```python
import torch

def _softmax(x, axis=-1):
    return torch.softmax(x, dim=axis)
def _gelu(x):
    return torch.nn.functional.gelu(x, approximate="tanh")
def _silu(x):
    return torch.nn.functional.silu(x)
def _sigmoid(x):
    return torch.sigmoid(x)
def _layernorm(x, axis=-1, eps=1e-5):
    m = x.mean(dim=axis, keepdim=True)
    v = x.var(dim=axis, keepdim=True, unbiased=False)
    return (x - m) / torch.sqrt(v + eps)
def _scatter_add(tgt, idx, src, axis=0):
    return tgt.clone().index_add_(axis, idx, src)
def _segment_sum(src, seg, n):
    out = torch.zeros((n,) + src.shape[1:], dtype=src.dtype)
    return out.index_add_(0, seg, src)
def _pad(x, pw):
    flat = tuple(v for pair in reversed(pw) for v in pair)
    return torch.nn.functional.pad(x, flat)

kernel_name = 'interleave_layers__ssm_conv_h3__mixer_channel_mlp__prompt'

def setup_inputs():

    _w = (lambda a: (lambda t: t.to(torch.bfloat16) if t.is_floating_point() else t)(torch.as_tensor(a)))
    def _A_setup():
        B, S, D = 1, 2048, 512
        ks = 4
        return {
            "q": _w((lambda *s: torch.randn(*s, dtype=torch.bfloat16) * 0.05)(B, S, D)),
            "k": _w((lambda *s: torch.randn(*s, dtype=torch.bfloat16) * 0.4)(B, S, D)),
            "v": _w((lambda *s: torch.randn(*s, dtype=torch.bfloat16) * 0.4)(B, S, D)),
            "shift_k": _w((lambda *s: torch.randn(*s, dtype=torch.bfloat16) * 0.4)(D, ks) * 0.5),
            "ssm_k": _w((lambda *s: torch.randn(*s, dtype=torch.bfloat16) * 0.4)(D, S) * (1.0 / S ** 0.5)),
            "ssm_D": _w((lambda *s: torch.randn(*s, dtype=torch.bfloat16) * 0.4)(D)),
        }
    _A_in = _A_setup()

    def _B_setup():
        B, S, D, F = 1, 2048, 512, 1792
        return {
            "x": _w((lambda *s: torch.randn(*s, dtype=torch.bfloat16) * 0.05)(B, S, D)),
            "w1": _w((lambda *s: torch.randn(*s, dtype=torch.bfloat16) * 0.8)(D, F) * (D ** -0.5)),
            "b1": _w((lambda *s: torch.randn(*s, dtype=torch.bfloat16) * 0.8)(F)),
            "w2": _w((lambda *s: torch.randn(*s, dtype=torch.bfloat16) * 0.8)(F, D) * (F ** -0.5)),
            "b2": _w((lambda *s: torch.randn(*s, dtype=torch.bfloat16) * 0.2)(D)),
        }
    _B_in = _B_setup()

    return {
        "A_q": _A_in["q"],
        "A_k": _A_in["k"],
        "A_v": _A_in["v"],
        "A_shift_k": _A_in["shift_k"],
        "A_ssm_k": _A_in["ssm_k"],
        "A_ssm_D": _A_in["ssm_D"],
        "B_x": _B_in["x"],
        "B_w1": _B_in["w1"],
        "B_b1": _B_in["b1"],
        "B_w2": _B_in["w2"],
        "B_b2": _B_in["b2"],
    }

def reference(A_q, A_k, A_v, A_shift_k, A_ssm_k, A_ssm_D, B_x, B_w1, B_b1, B_w2, B_b2):
    def _A_ref(q, k, v, shift_k, ssm_k, ssm_D):
        B, S, D = q.shape
        ks = shift_k.shape[-1]
        k_pad = _pad(k, ((0, 0), (ks - 1, 0), (0, 0)))
        k_shift = torch.zeros_like(k)
        for t in range(ks):
            k_shift = k_shift + k_pad[:, t:t + S, :] * shift_k[:, ks - 1 - t][None, None, :]
        kv = k_shift * v
        L = 2 * S
        kv_pad = _pad(kv, ((0, 0), (0, S), (0, 0)))
        kf_pad = _pad(ssm_k, ((0, 0), (0, S)))
        kv_f = (lambda x, axes=(-2,-1): torch.fft.rfft2(x.float(), dim=axes))(kv_pad[:, None, :, :], axes=(1, 2))
        kf_f = (lambda x, axes=(-2,-1): torch.fft.rfft2(x.float(), dim=axes))(kf_pad[:, None, :], axes=(1, 2))
        kf_f = (lambda x, *d: x.permute(*d))(kf_f, 1, 2, 0)
        y_f = kv_f * kf_f[None, :, :, :]
        y = (lambda x, s, axes=(-2,-1): torch.fft.irfft2(x, s=s, dim=axes).to(torch.bfloat16))(y_f, (1, L), axes=(1, 2))[:, 0, :S, :]
        y = y + kv * ssm_D[None, None, :]
        return q * y

    def _B_ref(x, w1, b1, w2, b2):
        y = _layernorm(x, axis=-1)
        h = _gelu(torch.einsum("bsd,df->bsf", y, w1) + b1)
        return torch.einsum("bsf,fd->bsd", h, w2) + b2

    x = A_q
    x = x + _A_ref(_layernorm(x, axis=-1), A_k, A_v, A_shift_k, A_ssm_k, A_ssm_D)
    x = x + _B_ref(_layernorm(x, axis=-1), B_w1, B_b1, B_w2, B_b2)
    x = x + _A_ref(_layernorm(x, axis=-1), A_k, A_v, A_shift_k, A_ssm_k, A_ssm_D)
    x = x + _B_ref(_layernorm(x, axis=-1), B_w1, B_b1, B_w2, B_b2)
    return x
```

```asm
; @launch grid=(256,1,1) block=(256,1,1) lds=163840
.amdgcn_target "amdgcn-amd-amdhsa--gfx950"
.text
.globl interleave_layers__ssm_conv_h3__mixer_channel_mlp__prompt_kernel
.p2align 8
.type interleave_layers__ssm_conv_h3__mixer_channel_mlp__prompt_kernel,@function
interleave_layers__ssm_conv_h3__mixer_channel_mlp__prompt_kernel:
  s_cmp_ge_u32 s2, 256
  s_cbranch_scc1 L_exit
  s_getpc_b64 s[92:93]
L_pc:
  s_lshr_b32 s3, s2, 3
  s_lshl_b32 s3, s3, 11
  v_and_b32 v2, 15, v0
  v_lshlrev_b32 v2, 7, v2
  v_add_u32 v2, s3, v2
  v_min_u32 v2, L_codeend-L_pc-4, v2
  v_and_b32 v2, -4, v2
  global_load_dword v254, v2, s[92:93]
  s_load_dwordx16 s[64:79], s[0:1], 0
  s_load_dwordx8 s[80:87], s[0:1], 64
  s_load_dwordx4 s[88:91], s[0:1], 96
  s_and_b32 s4, s2, 7
  s_lshr_b32 s5, s2, 3
  v_lshrrev_b32 v2, 6, v0
  v_and_b32 v1, 63, v0
  v_readfirstlane_b32 s6, v2
  s_lshl_b32 s52, s4, 5
  s_add_u32 s52, s52, s5
  s_mov_b32 s55, 4096
  s_mov_b32 s63, 0xffff
  s_mov_b32 s92, 0xffff0000
  s_mov_b32 s97, 0x3727c5ac
  s_lshr_b32 s93, s5, 4
  s_and_b32 s94, s5, 15
  s_lshr_b32 s95, s5, 3
  s_and_b32 s96, s5, 7
  s_getreg_b32 s101, hwreg(HW_REG_XCC_ID)
  s_and_b32 s101, s101, 15
  s_mov_b32 s100, 0
  v_and_b32 v2, 31, v0
  v_lshrrev_b32 v3, 5, v0
  s_lshl_b32 s57, s5, 16
  s_lshl_b32 s58, s4, 7
  s_add_u32 s57, s57, s58
  v_lshlrev_b32 v4, 13, v3
  v_lshl_add_u32 v4, v2, 2, v4
  v_add_u32 v4, s57, v4
  v_subrev_u32 v5, 3072, v4
  v_cmp_gt_u32 vcc, 1024, v4
  v_mov_b32 v6, 0x40000000
  s_nop 0
  v_cndmask_b32 v5, v5, v6, vcc
  s_lshl_b32 s59, s4, 9
  v_lshlrev_b32 v6, 4, v2
  s_waitcnt lgkmcnt(0)
  s_mov_b32 s12, s66
  s_mov_b32 s13, s67
  s_mov_b32 s14, 2097152
  s_mov_b32 s15, 0x20000
  s_mov_b32 s16, s68
  s_mov_b32 s17, s69
  s_mov_b32 s18, 2097152
  s_mov_b32 s19, 0x20000
  s_mov_b32 s40, s70
  s_mov_b32 s41, s71
  s_mov_b32 s42, 4096
  s_mov_b32 s43, 0x20000
  buffer_load_dword v8, v5, s[12:15], 0 offen offset:0
  buffer_load_dword v9, v5, s[12:15], 0 offen offset:1024
  buffer_load_dword v10, v5, s[12:15], 0 offen offset:2048
  buffer_load_dword v11, v4, s[12:15], 0 offen offset:0
  buffer_load_dword v12, v4, s[12:15], 0 offen offset:1024
  buffer_load_dword v13, v4, s[12:15], 0 offen offset:2048
  buffer_load_dword v14, v4, s[12:15], 0 offen offset:3072
  buffer_load_dword v15, v4, s[12:15], s55 offen offset:0
  buffer_load_dword v16, v4, s[12:15], s55 offen offset:1024
  buffer_load_dword v17, v4, s[12:15], s55 offen offset:2048
  buffer_load_dword v18, v4, s[12:15], s55 offen offset:3072
  buffer_load_dword v20, v4, s[16:19], 0 offen offset:0
  buffer_load_dword v21, v4, s[16:19], 0 offen offset:1024
  buffer_load_dword v22, v4, s[16:19], 0 offen offset:2048
  buffer_load_dword v23, v4, s[16:19], 0 offen offset:3072
  buffer_load_dword v24, v4, s[16:19], s55 offen offset:0
  buffer_load_dword v25, v4, s[16:19], s55 offen offset:1024
  buffer_load_dword v26, v4, s[16:19], s55 offen offset:2048
  buffer_load_dword v27, v4, s[16:19], s55 offen offset:3072
  buffer_load_dwordx4 v[28:31], v6, s[40:43], s59 offen
  s_load_dword s98, s[90:91], 0
  s_lshl_b32 s57, s4, 7
  s_lshl_b32 s58, s5, 2
  s_add_u32 s57, s57, s58
  s_load_dword s53, s[74:75], s57
  s_mov_b32 s32, s90
  s_mov_b32 s33, s91
  s_mov_b32 s34, 44040192
  s_mov_b32 s35, 0x20000
  v_min_u32 v37, 127, v0
  v_lshlrev_b32 v37, 7, v37
  s_lshl_b32 s57, s52, 14
  s_add_u32 s57, s57, 2097152
  buffer_load_dword v254, v37, s[32:35], s57 offen
  s_mov_b32 s20, s72
  s_mov_b32 s21, s73
  s_mov_b32 s22, 2097152
  s_mov_b32 s23, 0x20000
  s_mov_b32 s8, s64
  s_mov_b32 s9, s65
  s_mov_b32 s10, 2097152
  s_mov_b32 s11, 0x20000
  v_lshlrev_b32 v6, 4, v0
  v_sub_u32 v7, 4080, v6
  v_sub_u32 v6, 4064, v6
  v_cmp_eq_u32 vcc, 255, v0
  v_mov_b32 v32, 0x40000000
  s_nop 0
  v_cndmask_b32 v6, v6, v32, vcc
  s_lshl_b32 s57, s4, 18
  s_lshl_b32 s58, s5, 13
  s_add_u32 s57, s57, s58
  s_add_u32 s58, s57, 4096
  buffer_load_dwordx4 v[40:43], v6, s[20:23], s57 offen
  buffer_load_dwordx4 v[44:47], v7, s[20:23], s57 offen
  buffer_load_dwordx4 v[48:51], v6, s[20:23], s58 offen
  buffer_load_dwordx4 v[52:55], v7, s[20:23], s58 offen
  s_mov_b32 s24, s78
  s_mov_b32 s25, s79
  s_mov_b32 s26, 1835008
  s_mov_b32 s27, 0x20000
  s_mov_b32 s44, s80
  s_mov_b32 s45, s81
  s_mov_b32 s46, 3584
  s_mov_b32 s47, 0x20000
  s_mov_b32 s28, s82
  s_mov_b32 s29, s83
  s_mov_b32 s30, 1835008
  s_mov_b32 s31, 0x20000
  s_mov_b32 s48, s84
  s_mov_b32 s49, s85
  s_mov_b32 s50, 1024
  s_mov_b32 s51, 0x20000
  s_mov_b32 s36, s86
  s_mov_b32 s37, s87
  s_mov_b32 s38, 2097152
  s_mov_b32 s39, 0x20000
  s_add_u32 s86, s6, s96
  s_and_b32 s86, s86, 3
  v_min_u32 v36, 13, v1
  s_mul_i32 s57, s52, 56
  s_mul_i32 s58, s6, 14
  s_add_u32 s57, s57, s58
  s_lshl_b32 s57, s57, 7
  v_lshlrev_b32 v36, 7, v36
  buffer_load_dword v254, v36, s[24:27], s57 offen
  v_lshrrev_b32 v4, 2, v1
  v_lshlrev_b32 v4, 14, v4
  v_and_b32 v5, 3, v1
  v_lshl_add_u32 v4, v5, 4, v4
  s_lshl_b32 s57, s4, 19
  s_lshl_b32 s58, s5, 9
  s_add_u32 s57, s57, s58
  s_lshl_b32 s58, s6, 7
  s_add_u32 s57, s57, s58
  s_add_u32 s57, s57, 2097152
  s_add_u32 s58, s57, 262144
  s_mul_i32 s62, s6, 28672
  s_add_u32 s62, s62, 26624
  v_lshlrev_b32 v6, 5, v1
  v_add_u32 v6, s62, v6
  s_waitcnt vmcnt(6)
  v_lshlrev_b32 v56, 16, v28
  v_lshlrev_b32 v57, 16, v30
  v_and_b32 v58, s92, v28
  v_and_b32 v59, s92, v30
  v_lshlrev_b32 v60, 16, v29
  v_lshlrev_b32 v61, 16, v31
  v_and_b32 v62, s92, v29
  v_and_b32 v63, s92, v31
  v_lshlrev_b32 v64, 16, v8
  v_and_b32 v65, s92, v8
  v_lshlrev_b32 v66, 16, v9
  v_and_b32 v67, s92, v9
  v_lshlrev_b32 v68, 16, v10
  v_and_b32 v69, s92, v10
  v_lshlrev_b32 v70, 16, v11
  v_and_b32 v71, s92, v11
  v_lshlrev_b32 v72, 16, v12
  v_and_b32 v73, s92, v12
  v_lshlrev_b32 v74, 16, v13
  v_and_b32 v75, s92, v13
  v_lshlrev_b32 v76, 16, v14
  v_and_b32 v77, s92, v14
  v_lshlrev_b32 v78, 16, v15
  v_and_b32 v79, s92, v15
  v_lshlrev_b32 v80, 16, v16
  v_and_b32 v81, s92, v16
  v_lshlrev_b32 v82, 16, v17
  v_and_b32 v83, s92, v17
  v_lshlrev_b32 v84, 16, v18
  v_and_b32 v85, s92, v18
  v_pk_mul_f32 v[88:89], v[70:71], v[56:57]
  v_pk_mul_f32 v[90:91], v[72:73], v[56:57]
  v_pk_mul_f32 v[92:93], v[74:75], v[56:57]
  v_pk_mul_f32 v[94:95], v[76:77], v[56:57]
  v_pk_mul_f32 v[96:97], v[78:79], v[56:57]
  v_pk_mul_f32 v[98:99], v[80:81], v[56:57]
  v_pk_mul_f32 v[100:101], v[82:83], v[56:57]
  v_pk_mul_f32 v[102:103], v[84:85], v[56:57]
  v_pk_fma_f32 v[88:89], v[68:69], v[58:59], v[88:89]
  v_pk_fma_f32 v[90:91], v[70:71], v[58:59], v[90:91]
  v_pk_fma_f32 v[92:93], v[72:73], v[58:59], v[92:93]
  v_pk_fma_f32 v[94:95], v[74:75], v[58:59], v[94:95]
  v_pk_fma_f32 v[96:97], v[76:77], v[58:59], v[96:97]
  v_pk_fma_f32 v[98:99], v[78:79], v[58:59], v[98:99]
  v_pk_fma_f32 v[100:101], v[80:81], v[58:59], v[100:101]
  v_pk_fma_f32 v[102:103], v[82:83], v[58:59], v[102:103]
  v_pk_fma_f32 v[88:89], v[66:67], v[60:61], v[88:89]
  v_pk_fma_f32 v[90:91], v[68:69], v[60:61], v[90:91]
  v_pk_fma_f32 v[92:93], v[70:71], v[60:61], v[92:93]
  v_pk_fma_f32 v[94:95], v[72:73], v[60:61], v[94:95]
  v_pk_fma_f32 v[96:97], v[74:75], v[60:61], v[96:97]
  v_pk_fma_f32 v[98:99], v[76:77], v[60:61], v[98:99]
  v_pk_fma_f32 v[100:101], v[78:79], v[60:61], v[100:101]
  v_pk_fma_f32 v[102:103], v[80:81], v[60:61], v[102:103]
  v_pk_fma_f32 v[88:89], v[64:65], v[62:63], v[88:89]
  v_pk_fma_f32 v[90:91], v[66:67], v[62:63], v[90:91]
  v_pk_fma_f32 v[92:93], v[68:69], v[62:63], v[92:93]
  v_pk_fma_f32 v[94:95], v[70:71], v[62:63], v[94:95]
  v_pk_fma_f32 v[96:97], v[72:73], v[62:63], v[96:97]
  v_pk_fma_f32 v[98:99], v[74:75], v[62:63], v[98:99]
  v_pk_fma_f32 v[100:101], v[76:77], v[62:63], v[100:101]
  v_pk_fma_f32 v[102:103], v[78:79], v[62:63], v[102:103]
  v_lshlrev_b32 v64, 16, v20
  v_and_b32 v65, s92, v20
  v_lshlrev_b32 v66, 16, v21
  v_and_b32 v67, s92, v21
  v_lshlrev_b32 v68, 16, v22
  v_and_b32 v69, s92, v22
  v_lshlrev_b32 v70, 16, v23
  v_and_b32 v71, s92, v23
  v_lshlrev_b32 v72, 16, v24
  v_and_b32 v73, s92, v24
  v_lshlrev_b32 v74, 16, v25
  v_and_b32 v75, s92, v25
  v_lshlrev_b32 v76, 16, v26
  v_and_b32 v77, s92, v26
  v_lshlrev_b32 v78, 16, v27
  v_and_b32 v79, s92, v27
  v_pk_mul_f32 v[88:89], v[88:89], v[64:65]
  v_pk_mul_f32 v[90:91], v[90:91], v[66:67]
  v_pk_mul_f32 v[92:93], v[92:93], v[68:69]
  v_pk_mul_f32 v[94:95], v[94:95], v[70:71]
  v_pk_mul_f32 v[96:97], v[96:97], v[72:73]
  v_pk_mul_f32 v[98:99], v[98:99], v[74:75]
  v_pk_mul_f32 v[100:101], v[100:101], v[76:77]
  v_pk_mul_f32 v[102:103], v[102:103], v[78:79]
  v_cvt_pk_bf16_f32 v64, v88, v90
  v_cvt_pk_bf16_f32 v65, v92, v94
  v_cvt_pk_bf16_f32 v66, v96, v98
  v_cvt_pk_bf16_f32 v67, v100, v102
  v_cvt_pk_bf16_f32 v68, v89, v91
  v_cvt_pk_bf16_f32 v69, v93, v95
  v_cvt_pk_bf16_f32 v70, v97, v99
  v_cvt_pk_bf16_f32 v71, v101, v103
  s_waitcnt lgkmcnt(0)
  s_and_b32 s98, s98, 0xfffffff0
  s_add_u32 s98, s98, 0x9e3779b0
  s_mul_i32 s91, s98, 0x85ebca6b
  s_add_u32 s91, s91, 0xc2b2ae35
  s_xor_b32 s99, s91, s101
  ds_write_b128 v6, v[64:67]
  ds_write_b128 v6, v[68:71] offset:16
  v_mov_b32 v178, s98
  v_mov_b32 v179, s99
  v_mov_b32 v182, s98
  v_mov_b32 v183, s99
  v_mov_b32 v186, s98
  v_mov_b32 v187, s99
  v_mov_b32 v190, s98
  v_mov_b32 v191, s99
  v_lshlrev_b32 v7, 3, v1
  v_add_u32 v7, s62, v7
  ds_read_b64 v[176:177], v7 offset:0
  ds_read_b64 v[180:181], v7 offset:512
  ds_read_b64 v[184:185], v7 offset:1024
  ds_read_b64 v[188:189], v7 offset:1536
  s_waitcnt lgkmcnt(0)
  buffer_store_dwordx4 v[176:179], v4, s[32:35], s57 offen offset:0
  buffer_store_dwordx4 v[180:183], v4, s[32:35], s58 offen offset:0
  buffer_store_dwordx4 v[184:187], v4, s[32:35], s57 offen offset:64
  buffer_store_dwordx4 v[188:191], v4, s[32:35], s58 offen offset:64
  v_mov_b32 v56, 0
  v_mov_b32 v57, 0
  v_mov_b32 v58, 0
  v_mov_b32 v59, 0
  v_lshrrev_b32 v2, 5, v0
  v_mul_u32_u24 v2, 1536, v2
  v_and_b32 v3, 31, v0
  v_lshl_add_u32 v2, v3, 4, v2
  v_add_u32 v2, 147968, v2
  ds_write_b128 v2, v[56:59]
  v_bfe_u32 v2, v1, 2, 3
  v_mul_u32_u24 v2, 4160, v2
  v_and_b32 v3, 3, v1
  v_lshl_add_u32 v2, v3, 4, v2
  v_add_u32 v2, 118784, v2
  ds_write_b128 v2, v[56:59]
  v_lshlrev_b32 v2, 4, v0
  v_add_u32 v2, 114688, v2
  s_waitcnt vmcnt(5)
  v_alignbit_b32 v60, v47, v47, 16
  v_alignbit_b32 v61, v46, v46, 16
  v_alignbit_b32 v62, v45, v45, 16
  v_alignbit_b32 v63, v44, v44, 16
  v_alignbit_b32 v64, v46, v46, 16
  v_alignbit_b32 v65, v45, v45, 16
  v_alignbit_b32 v66, v44, v44, 16
  v_alignbit_b32 v67, v43, v43, 16
  v_bfi_b32 v68, s63, v47, v46
  v_bfi_b32 v69, s63, v46, v45
  v_bfi_b32 v70, s63, v45, v44
  v_bfi_b32 v71, s63, v44, v43
  v_bfi_b32 v72, s63, v46, v45
  v_bfi_b32 v73, s63, v45, v44
  v_bfi_b32 v74, s63, v44, v43
  v_bfi_b32 v75, s63, v43, v42
  ds_write_b128 v2, v[60:63] offset:0
  ds_write_b128 v2, v[64:67] offset:8320
  ds_write_b128 v2, v[68:71] offset:4160
  ds_write_b128 v2, v[72:75] offset:12480
  v_alignbit_b32 v80, v55, v55, 16
  v_alignbit_b32 v81, v54, v54, 16
  v_alignbit_b32 v82, v53, v53, 16
  v_alignbit_b32 v83, v52, v52, 16
  v_alignbit_b32 v84, v54, v54, 16
  v_alignbit_b32 v85, v53, v53, 16
  v_alignbit_b32 v86, v52, v52, 16
  v_alignbit_b32 v87, v51, v51, 16
  v_bfi_b32 v88, s63, v55, v54
  v_bfi_b32 v89, s63, v54, v53
  v_bfi_b32 v90, s63, v53, v52
  v_bfi_b32 v91, s63, v52, v51
  v_bfi_b32 v92, s63, v54, v53
  v_bfi_b32 v93, s63, v53, v52
  v_bfi_b32 v94, s63, v52, v51
  v_bfi_b32 v95, s63, v51, v50
  ds_write_b128 v2, v[80:83] offset:16640
  ds_write_b128 v2, v[84:87] offset:24960
  ds_write_b128 v2, v[88:91] offset:20800
  ds_write_b128 v2, v[92:95] offset:29120
  v_lshlrev_b32 v2, 4, v1
  s_lshl_b32 s57, s52, 14
  s_add_u32 s57, s57, 2097152
  s_lshl_b32 s58, s6, 12
  s_add_u32 s57, s57, s58
  v_bfe_u32 v3, v1, 1, 1
  v_mul_u32_u24 v3, 6144, v3
  v_bfe_u32 v4, v1, 2, 2
  v_mul_u32_u24 v4, 1536, v4
  v_add_u32 v3, v3, v4
  v_lshrrev_b32 v4, 4, v1
  v_lshl_add_u32 v3, v4, 4, v3
  v_and_b32 v4, 1, v1
  v_lshl_add_u32 v3, v4, 3, v3
  s_lshl_b32 s58, s6, 8
  s_add_u32 s58, s58, 148480
  v_add_u32 v3, s58, v3
  s_lshl_b32 s58, s6, 2
  s_add_u32 s58, s58, 160256
  v_mov_b32 v24, s58
  v_mov_b32 v26, 160256
  s_mov_b32 s87, 0
  s_mov_b32 s56, 64
L_tp_4:
  buffer_load_dwordx4 v[8:11], v2, s[32:35], s57 offen offset:0 sc1
  buffer_load_dwordx4 v[12:15], v2, s[32:35], s57 offen offset:1024 sc1
  buffer_load_dwordx4 v[16:19], v2, s[32:35], s57 offen offset:2048 sc1
  buffer_load_dwordx4 v[20:23], v2, s[32:35], s57 offen offset:3072 sc1
  s_waitcnt vmcnt(0)
  v_cmp_ne_u64 s[64:65], s[98:99], v[10:11]
  v_cmp_ne_u64 s[66:67], s[98:99], v[14:15]
  v_cmp_ne_u64 s[68:69], s[98:99], v[18:19]
  v_cmp_ne_u64 s[70:71], s[98:99], v[22:23]
  s_or_b64 s[64:65], s[64:65], s[66:67]
  s_or_b64 s[68:69], s[68:69], s[70:71]
  s_or_b64 s[64:65], s[64:65], s[68:69]
  s_cbranch_scc0 L_hopa_ok_1
  s_sub_u32 s56, s56, 1
  s_cbranch_scc1 L_tpo_5
  s_sleep 1
  s_branch L_tp_4
L_tpo_5:
  s_mov_b32 s87, 1
  s_branch L_hopa_chk_2
L_hopa_ok_1:
  ds_write_b64 v3, v[8:9] offset:0
  ds_write_b64 v3, v[12:13] offset:64
  ds_write_b64 v3, v[16:17] offset:128
  ds_write_b64 v3, v[20:21] offset:192
L_hopa_chk_2:
  v_mov_b32 v25, s87
  ds_write_b32 v24, v25
  s_waitcnt lgkmcnt(0)
  s_barrier
  ds_read_b128 v[28:31], v26
  s_waitcnt lgkmcnt(0)
  v_or_b32 v28, v28, v29
  v_or_b32 v30, v30, v31
  v_or_b32 v28, v28, v30
  s_nop 0
  v_readfirstlane_b32 s76, v28
  s_nop 0
  s_cmp_eq_u32 s76, 0
  s_cbranch_scc1 L_hopa_done_3
  v_mov_b32 v179, s91
  v_mov_b32 v183, s91
  v_mov_b32 v187, s91
  v_mov_b32 v191, s91
  v_lshlrev_b32 v5, 4, v1
  s_lshl_b32 s61, s52, 14
  s_lshl_b32 s62, s6, 12
  s_add_u32 s61, s61, s62
  s_add_u32 s61, s61, 37748736
  buffer_store_dwordx4 v[176:179], v5, s[32:35], s61 offen offset:0 sc1
  buffer_store_dwordx4 v[180:183], v5, s[32:35], s61 offen offset:1024 sc1
  buffer_store_dwordx4 v[184:187], v5, s[32:35], s61 offen offset:2048 sc1
  buffer_store_dwordx4 v[188:191], v5, s[32:35], s61 offen offset:3072 sc1
  s_cmp_eq_u32 s87, 0
  s_cbranch_scc1 L_hopa_have_6
  v_lshrrev_b32 v24, 5, v1
  v_lshlrev_b32 v24, 14, v24
  v_bfe_u32 v4, v1, 2, 3
  v_lshl_add_u32 v24, v4, 11, v24
  v_and_b32 v4, 3, v1
  v_lshl_add_u32 v24, v4, 4, v24
  s_lshl_b32 s73, s4, 19
  s_lshl_b32 s58, s6, 17
  s_add_u32 s73, s73, s58
  s_lshl_b32 s58, s5, 6
  s_add_u32 s73, s73, s58
  s_add_u32 s73, s73, 37748736
  s_add_u32 s74, s73, 32768
  s_add_u32 s75, s73, 65536
  s_add_u32 s60, s73, 98304
  s_mov_b32 s56, 131072
  s_mov_b32 s77, s99
L_hopa_fb_8:
  s_mov_b32 s99, s91
  buffer_load_dwordx4 v[8:11], v24, s[32:35], s73 offen offset:0 sc1
  buffer_load_dwordx4 v[12:15], v24, s[32:35], s74 offen offset:0 sc1
  buffer_load_dwordx4 v[16:19], v24, s[32:35], s75 offen offset:0 sc1
  buffer_load_dwordx4 v[20:23], v24, s[32:35], s60 offen offset:0 sc1
  s_waitcnt vmcnt(0)
  v_cmp_ne_u64 s[64:65], s[98:99], v[10:11]
  v_cmp_ne_u64 s[66:67], s[98:99], v[14:15]
  v_cmp_ne_u64 s[68:69], s[98:99], v[18:19]
  v_cmp_ne_u64 s[70:71], s[98:99], v[22:23]
  s_or_b64 s[64:65], s[64:65], s[66:67]
  s_or_b64 s[68:69], s[68:69], s[70:71]
  s_or_b64 s[64:65], s[64:65], s[68:69]
  s_cbranch_scc0 L_hopa_got_7
  s_mov_b32 s99, s77
  buffer_load_dwordx4 v[8:11], v2, s[32:35], s57 offen offset:0 sc1
  buffer_load_dwordx4 v[12:15], v2, s[32:35], s57 offen offset:1024 sc1
  buffer_load_dwordx4 v[16:19], v2, s[32:35], s57 offen offset:2048 sc1
  buffer_load_dwordx4 v[20:23], v2, s[32:35], s57 offen offset:3072 sc1
  s_waitcnt vmcnt(0)
  v_cmp_ne_u64 s[64:65], s[98:99], v[10:11]
  v_cmp_ne_u64 s[66:67], s[98:99], v[14:15]
  v_cmp_ne_u64 s[68:69], s[98:99], v[18:19]
  v_cmp_ne_u64 s[70:71], s[98:99], v[22:23]
  s_or_b64 s[64:65], s[64:65], s[66:67]
  s_or_b64 s[68:69], s[68:69], s[70:71]
  s_or_b64 s[64:65], s[64:65], s[68:69]
  s_cbranch_scc0 L_hopa_got_7
  s_sub_u32 s56, s56, 1
  s_cbranch_scc1 L_hopa_tmo_9
  s_sleep 2
  s_branch L_hopa_fb_8
L_hopa_tmo_9:
L_hopa_got_7:
  ds_write_b64 v3, v[8:9] offset:0
  ds_write_b64 v3, v[12:13] offset:64
  ds_write_b64 v3, v[16:17] offset:128
  ds_write_b64 v3, v[20:21] offset:192
L_hopa_have_6:
  s_waitcnt vmcnt(0) lgkmcnt(0)
  s_barrier
L_hopa_done_3:
  s_mov_b32 s99, s91
  v_min_u32 v36, 13, v1
  s_mul_i32 s57, s52, 56
  s_mul_i32 s58, s6, 14
  s_add_u32 s57, s57, s58
  s_lshl_b32 s57, s57, 7
  v_lshlrev_b32 v36, 7, v36
  buffer_load_dword v254, v36, s[28:31], s57 offen
  s_xor_b32 s99, s99, 0x11111111
  v_lshrrev_b32 v33, 5, v0
  v_lshlrev_b32 v33, 10, v33
  v_bfe_u32 v34, v0, 2, 3
  v_lshl_add_u32 v33, v34, 7, v33
  v_and_b32 v34, 3, v0
  v_lshl_add_u32 v33, v34, 3, v33
  s_lshl_b32 s57, s52, 13
  buffer_load_dwordx2 a[224:225], v33, s[8:11], s57 offen offset:0
  buffer_load_dwordx2 a[226:227], v33, s[8:11], s57 offen offset:32
  buffer_load_dwordx2 a[228:229], v33, s[8:11], s57 offen offset:64
  buffer_load_dwordx2 a[230:231], v33, s[8:11], s57 offen offset:96
  s_mov_b32 s57, 4682
  v_add_u32 v34, 0, v1
  v_mul_u32_u24 v35, s57, v34
  v_lshrrev_b32 v35, 16, v35
  v_mul_u32_u24 v36, 14, v35
  v_sub_u32 v36, v34, v36
  v_mul_u32_u24 v35, 3584, v35
  v_lshl_add_u32 v192, v36, 4, v35
  v_add_u32 v34, 64, v1
  v_mul_u32_u24 v35, s57, v34
  v_lshrrev_b32 v35, 16, v35
  v_mul_u32_u24 v36, 14, v35
  v_sub_u32 v36, v34, v36
  v_mul_u32_u24 v35, 3584, v35
  v_lshl_add_u32 v193, v36, 4, v35
  v_add_u32 v34, 128, v1
  v_mul_u32_u24 v35, s57, v34
  v_lshrrev_b32 v35, 16, v35
  v_mul_u32_u24 v36, 14, v35
  v_sub_u32 v36, v34, v36
  v_mul_u32_u24 v35, 3584, v35
  v_lshl_add_u32 v194, v36, 4, v35
  v_add_u32 v34, 192, v1
  v_mul_u32_u24 v35, s57, v34
  v_lshrrev_b32 v35, 16, v35
  v_mul_u32_u24 v36, 14, v35
  v_sub_u32 v36, v34, v36
  v_mul_u32_u24 v35, 3584, v35
  v_lshl_add_u32 v195, v36, 4, v35
  v_add_u32 v34, 256, v1
  v_mul_u32_u24 v35, s57, v34
  v_lshrrev_b32 v35, 16, v35
  v_mul_u32_u24 v36, 14, v35
  v_sub_u32 v36, v34, v36
  v_mul_u32_u24 v35, 3584, v35
  v_lshl_add_u32 v196, v36, 4, v35
  v_add_u32 v34, 320, v1
  v_mul_u32_u24 v35, s57, v34
  v_lshrrev_b32 v35, 16, v35
  v_mul_u32_u24 v36, 14, v35
  v_sub_u32 v36, v34, v36
  v_mul_u32_u24 v35, 3584, v35
  v_lshl_add_u32 v197, v36, 4, v35
  v_add_u32 v34, 384, v1
  v_mul_u32_u24 v35, s57, v34
  v_lshrrev_b32 v35, 16, v35
  v_mul_u32_u24 v36, 14, v35
  v_sub_u32 v36, v34, v36
  v_mul_u32_u24 v35, 3584, v35
  v_lshl_add_u32 v198, v36, 4, v35
  s_mul_i32 s88, s6, 458752
  s_mul_i32 s59, s94, 224
  s_add_u32 s88, s88, s59
  s_mul_i32 s89, s6, 28672
  s_and_b32 s58, s6, 1
  s_lshr_b32 s61, s6, 1
  v_and_b32 v4, 3, v1
  v_sub_u32 v4, 3, v4
  v_mul_u32_u24 v2, 4160, v4
  v_bfe_u32 v4, v1, 2, 3
  v_lshlrev_b32 v4, 3, v4
  v_sub_u32 v2, v2, v4
  v_lshrrev_b32 v5, 5, v1
  v_lshl_add_u32 v2, v5, 4, v2
  s_mul_i32 s57, s58, 16640
  s_lshl_b32 s62, s61, 10
  s_sub_u32 s57, s57, s62
  s_add_u32 s57, s57, 115768
  v_add_u32 v2, s57, v2
  v_mul_u32_u24 v3, 1536, v5
  v_and_b32 v4, 31, v1
  v_lshl_add_u32 v3, v4, 4, v3
  s_mul_i32 s57, s58, 6144
  s_lshl_b32 s62, s61, 8
  s_sub_u32 s57, s57, s62
  s_add_u32 s57, s57, 148240
  v_add_u32 v3, s57, v3
  ds_read_b64 v[96:97], v2 offset:3040
  ds_read_b64 v[98:99], v2 offset:3048
  ds_read_b128 v[100:103], v3 offset:3824
  ds_read_b128 v[104:107], v3 offset:3312
  ds_read_b64 v[108:109], v2 offset:992
  ds_read_b64 v[110:111], v2 offset:1000
  ds_read_b64 v[112:113], v2 offset:3008
  ds_read_b64 v[114:115], v2 offset:3016
  ds_read_b128 v[116:119], v3 offset:752
  ds_read_b128 v[120:123], v3 offset:240
  ds_read_b64 v[124:125], v2 offset:960
  ds_read_b64 v[126:127], v2 offset:968
  s_waitcnt lgkmcnt(6)
  v_mfma_f32_32x32x16_bf16 v[80:95], v[96:99], v[100:103], 0
  ds_read_b64 v[128:129], v2 offset:2976
  ds_read_b64 v[130:131], v2 offset:2984
  ds_read_b128 v[132:135], v3 offset:3808
  ds_read_b128 v[136:139], v3 offset:3296
  ds_read_b64 v[140:141], v2 offset:928
  ds_read_b64 v[142:143], v2 offset:936
  v_mfma_f32_32x32x16_bf16 v[64:79], v[96:99], v[104:107], 0
  s_add_u32 m0, s89, 0
  s_nop 0
  buffer_load_dwordx4 v192, s[24:27], s88 offen lds
  v_mfma_f32_32x32x16_bf16 v[80:95], v[108:111], v[104:107], v[80:95]
  s_waitcnt lgkmcnt(6)
  v_mfma_f32_32x32x16_bf16 v[80:95], v[112:115], v[116:119], v[80:95]
  ds_read_b64 v[96:97], v2 offset:2944
  ds_read_b64 v[98:99], v2 offset:2952
  ds_read_b128 v[100:103], v3 offset:736
  ds_read_b128 v[104:107], v3 offset:224
  ds_read_b64 v[108:109], v2 offset:896
  ds_read_b64 v[110:111], v2 offset:904
  v_mfma_f32_32x32x16_bf16 v[64:79], v[112:115], v[120:123], v[64:79]
  s_add_u32 m0, s89, 1024
  s_nop 0
  buffer_load_dwordx4 v193, s[24:27], s88 offen lds
  v_mfma_f32_32x32x16_bf16 v[80:95], v[124:127], v[120:123], v[80:95]
  s_waitcnt lgkmcnt(6)
  v_mfma_f32_32x32x16_bf16 v[80:95], v[128:131], v[132:135], v[80:95]
  ds_read_b64 v[112:113], v2 offset:2912
  ds_read_b64 v[114:115], v2 offset:2920
  ds_read_b128 v[116:119], v3 offset:3792
  ds_read_b128 v[120:123], v3 offset:3280
  ds_read_b64 v[124:125], v2 offset:864
  ds_read_b64 v[126:127], v2 offset:872
  v_mfma_f32_32x32x16_bf16 v[64:79], v[128:131], v[136:139], v[64:79]
  s_add_u32 m0, s89, 2048
  s_nop 0
  buffer_load_dwordx4 v194, s[24:27], s88 offen lds
  v_mfma_f32_32x32x16_bf16 v[80:95], v[140:143], v[136:139], v[80:95]
  s_waitcnt lgkmcnt(6)
  v_mfma_f32_32x32x16_bf16 v[80:95], v[96:99], v[100:103], v[80:95]
  ds_read_b64 v[128:129], v2 offset:2880
  ds_read_b64 v[130:131], v2 offset:2888
  ds_read_b128 v[132:135], v3 offset:720
  ds_read_b128 v[136:139], v3 offset:208
  ds_read_b64 v[140:141], v2 offset:832
  ds_read_b64 v[142:143], v2 offset:840
  v_mfma_f32_32x32x16_bf16 v[64:79], v[96:99], v[104:107], v[64:79]
  s_add_u32 m0, s89, 3072
  s_nop 0
  buffer_load_dwordx4 v195, s[24:27], s88 offen lds
  v_mfma_f32_32x32x16_bf16 v[80:95], v[108:111], v[104:107], v[80:95]
  s_waitcnt lgkmcnt(6)
  v_mfma_f32_32x32x16_bf16 v[80:95], v[112:115], v[116:119], v[80:95]
  ds_read_b64 v[96:97], v2 offset:2848
  ds_read_b64 v[98:99], v2 offset:2856
  ds_read_b128 v[100:103], v3 offset:3776
  ds_read_b128 v[104:107], v3 offset:3264
  ds_read_b64 v[108:109], v2 offset:800
  ds_read_b64 v[110:111], v2 offset:808
  v_mfma_f32_32x32x16_bf16 v[64:79], v[112:115], v[120:123], v[64:79]
  s_add_u32 m0, s89, 4096
  s_nop 0
  buffer_load_dwordx4 v196, s[24:27], s88 offen lds
  v_mfma_f32_32x32x16_bf16 v[80:95], v[124:127], v[120:123], v[80:95]
  s_waitcnt lgkmcnt(6)
  v_mfma_f32_32x32x16_bf16 v[80:95], v[128:131], v[132:135], v[80:95]
  ds_read_b64 v[112:113], v2 offset:2816
  ds_read_b64 v[114:115], v2 offset:2824
  ds_read_b128 v[116:119], v3 offset:704
  ds_read_b128 v[120:123], v3 offset:192
  ds_read_b64 v[124:125], v2 offset:768
  ds_read_b64 v[126:127], v2 offset:776
  v_mfma_f32_32x32x16_bf16 v[64:79], v[128:131], v[136:139], v[64:79]
  s_add_u32 m0, s89, 5120
  s_nop 0
  buffer_load_dwordx4 v197, s[24:27], s88 offen lds
  v_mfma_f32_32x32x16_bf16 v[80:95], v[140:143], v[136:139], v[80:95]
  s_waitcnt lgkmcnt(6)
  v_mfma_f32_32x32x16_bf16 v[80:95], v[96:99], v[100:103], v[80:95]
  ds_read_b64 v[128:129], v2 offset:2784
  ds_read_b64 v[130:131], v2 offset:2792
  ds_read_b128 v[132:135], v3 offset:3760
  ds_read_b128 v[136:139], v3 offset:3248
  ds_read_b64 v[140:141], v2 offset:736
  ds_read_b64 v[142:143], v2 offset:744
  v_mfma_f32_32x32x16_bf16 v[64:79], v[96:99], v[104:107], v[64:79]
  s_add_u32 m0, s89, 6144
  s_nop 0
  buffer_load_dwordx4 v198, s[24:27], s88 offen lds
  v_mfma_f32_32x32x16_bf16 v[80:95], v[108:111], v[104:107], v[80:95]
  s_waitcnt lgkmcnt(6)
  v_mfma_f32_32x32x16_bf16 v[80:95], v[112:115], v[116:119], v[80:95]
  ds_read_b64 v[96:97], v2 offset:2752
  ds_read_b64 v[98:99], v2 offset:2760
  ds_read_b128 v[100:103], v3 offset:688
  ds_read_b128 v[104:107], v3 offset:176
  ds_read_b64 v[108:109], v2 offset:704
  ds_read_b64 v[110:111], v2 offset:712
  v_mfma_f32_32x32x16_bf16 v[64:79], v[112:115], v[120:123], v[64:79]
  s_add_u32 s88, s88, 114688
  s_add_u32 m0, s89, 7168
  s_nop 0
  buffer_load_dwordx4 v192, s[24:27], s88 offen lds
  v_mfma_f32_32x32x16_bf16 v[80:95], v[124:127], v[120:123], v[80:95]
  s_waitcnt lgkmcnt(6)
  v_mfma_f32_32x32x16_bf16 v[80:95], v[128:131], v[132:135], v[80:95]
  ds_read_b64 v[112:113], v2 offset:2720
  ds_read_b64 v[114:115], v2 offset:2728
  ds_read_b128 v[116:119], v3 offset:3744
  ds_read_b128 v[120:123], v3 offset:3232
  ds_read_b64 v[124:125], v2 offset:672
  ds_read_b64 v[126:127], v2 offset:680
  v_mfma_f32_32x32x16_bf16 v[64:79], v[128:131], v[136:139], v[64:79]
  s_add_u32 m0, s89, 8192
  s_nop 0
  buffer_load_dwordx4 v193, s[24:27], s88 offen lds
  v_mfma_f32_32x32x16_bf16 v[80:95], v[140:143], v[136:139], v[80:95]
  s_waitcnt lgkmcnt(6)
  v_mfma_f32_32x32x16_bf16 v[80:95], v[96:99], v[100:103], v[80:95]
  ds_read_b64 v[128:129], v2 offset:2688
  ds_read_b64 v[130:131], v2 offset:2696
  ds_read_b128 v[132:135], v3 offset:672
  ds_read_b128 v[136:139], v3 offset:160
  ds_read_b64 v[140:141], v2 offset:640
  ds_read_b64 v[142:143], v2 offset:648
  v_mfma_f32_32x32x16_bf16 v[64:79], v[96:99], v[104:107], v[64:79]
  s_add_u32 m0, s89, 9216
  s_nop 0
  buffer_load_dwordx4 v194, s[24:27], s88 offen lds
  v_mfma_f32_32x32x16_bf16 v[80:95], v[108:111], v[104:107], v[80:95]
  s_waitcnt lgkmcnt(6)
  v_mfma_f32_32x32x16_bf16 v[80:95], v[112:115], v[116:119], v[80:95]
  ds_read_b64 v[96:97], v2 offset:2656
  ds_read_b64 v[98:99], v2 offset:2664
  ds_read_b128 v[100:103], v3 offset:3728
  ds_read_b128 v[104:107], v3 offset:3216
  ds_read_b64 v[108:109], v2 offset:608
  ds_read_b64 v[110:111], v2 offset:616
  v_mfma_f32_32x32x16_bf16 v[64:79], v[112:115], v[120:123], v[64:79]
  s_add_u32 m0, s89, 10240
  s_nop 0
  buffer_load_dwordx4 v195, s[24:27], s88 offen lds
  v_mfma_f32_32x32x16_bf16 v[80:95], v[124:127], v[120:123], v[80:95]
  s_waitcnt lgkmcnt(6)
  v_mfma_f32_32x32x16_bf16 v[80:95], v[128:131], v[132:135], v[80:95]
  ds_read_b64 v[112:113], v2 offset:2624
  ds_read_b64 v[114:115], v2 offset:2632
  ds_read_b128 v[116:119], v3 offset:656
  ds_read_b128 v[120:123], v3 offset:144
  ds_read_b64 v[124:125], v2 offset:576
  ds_read_b64 v[126:127], v2 offset:584
  v_mfma_f32_32x32x16_bf16 v[64:79], v[128:131], v[136:139], v[64:79]
  s_add_u32 m0, s89, 11264
  s_nop 0
  buffer_load_dwordx4 v196, s[24:27], s88 offen lds
  v_mfma_f32_32x32x16_bf16 v[80:95], v[140:143], v[136:139], v[80:95]
  s_waitcnt lgkmcnt(6)
  v_mfma_f32_32x32x16_bf16 v[80:95], v[96:99], v[100:103], v[80:95]
  ds_read_b64 v[128:129], v2 offset:2592
  ds_read_b64 v[130:131], v2 offset:2600
  ds_read_b128 v[132:135], v3 offset:3712
  ds_read_b128 v[136:139], v3 offset:3200
  ds_read_b64 v[140:141], v2 offset:544
  ds_read_b64 v[142:143], v2 offset:552
  v_mfma_f32_32x32x16_bf16 v[64:79], v[96:99], v[104:107], v[64:79]
  s_add_u32 m0, s89, 12288
  s_nop 0
  buffer_load_dwordx4 v197, s[24:27], s88 offen lds
  v_mfma_f32_32x32x16_bf16 v[80:95], v[108:111], v[104:107], v[80:95]
  s_waitcnt lgkmcnt(6)
  v_mfma_f32_32x32x16_bf16 v[80:95], v[112:115], v[116:119], v[80:95]
  ds_read_b64 v[96:97], v2 offset:2560
  ds_read_b64 v[98:99], v2 offset:2568
  ds_read_b128 v[100:103], v3 offset:640
  ds_read_b128 v[104:107], v3 offset:128
  ds_read_b64 v[108:109], v2 offset:512
  ds_read_b64 v[110:111], v2 offset:520
  v_mfma_f32_32x32x16_bf16 v[64:79], v[112:115], v[120:123], v[64:79]
  s_add_u32 m0, s89, 13312
  s_nop 0
  buffer_load_dwordx4 v198, s[24:27], s88 offen lds
  v_mfma_f32_32x32x16_bf16 v[80:95], v[124:127], v[120:123], v[80:95]
  s_waitcnt lgkmcnt(6)
  v_mfma_f32_32x32x16_bf16 v[80:95], v[128:131], v[132:135], v[80:95]
  ds_read_b64 v[112:113], v2 offset:2528
  ds_read_b64 v[114:115], v2 offset:2536
  ds_read_b128 v[116:119], v3 offset:3696
  ds_read_b128 v[120:123], v3 offset:3184
  ds_read_b64 v[124:125], v2 offset:480
  ds_read_b64 v[126:127], v2 offset:488
  v_mfma_f32_32x32x16_bf16 v[64:79], v[128:131], v[136:139], v[64:79]
  s_add_u32 s88, s88, 114688
  s_add_u32 m0, s89, 14336
  s_nop 0
  buffer_load_dwordx4 v192, s[24:27], s88 offen lds
  v_mfma_f32_32x32x16_bf16 v[80:95], v[140:143], v[136:139], v[80:95]
  s_waitcnt lgkmcnt(6)
  v_mfma_f32_32x32x16_bf16 v[80:95], v[96:99], v[100:103], v[80:95]
  ds_read_b64 v[128:129], v2 offset:2496
  ds_read_b64 v[130:131], v2 offset:2504
  ds_read_b128 v[132:135], v3 offset:624
  ds_read_b128 v[136:139], v3 offset:112
  ds_read_b64 v[140:141], v2 offset:448
  ds_read_b64 v[142:143], v2 offset:456
  v_mfma_f32_32x32x16_bf16 v[64:79], v[96:99], v[104:107], v[64:79]
  s_add_u32 m0, s89, 15360
  s_nop 0
  buffer_load_dwordx4 v193, s[24:27], s88 offen lds
  v_mfma_f32_32x32x16_bf16 v[80:95], v[108:111], v[104:107], v[80:95]
  s_waitcnt lgkmcnt(6)
  v_mfma_f32_32x32x16_bf16 v[80:95], v[112:115], v[116:119], v[80:95]
  ds_read_b64 v[96:97], v2 offset:2464
  ds_read_b64 v[98:99], v2 offset:2472
  ds_read_b128 v[100:103], v3 offset:3680
  ds_read_b128 v[104:107], v3 offset:3168
  ds_read_b64 v[108:109], v2 offset:416
  ds_read_b64 v[110:111], v2 offset:424
  v_mfma_f32_32x32x16_bf16 v[64:79], v[112:115], v[120:123], v[64:79]
  s_add_u32 m0, s89, 16384
  s_nop 0
  buffer_load_dwordx4 v194, s[24:27], s88 offen lds
  v_mfma_f32_32x32x16_bf16 v[80:95], v[124:127], v[120:123], v[80:95]
  s_waitcnt lgkmcnt(6)
  v_mfma_f32_32x32x16_bf16 v[80:95], v[128:131], v[132:135], v[80:95]
  ds_read_b64 v[112:113], v2 offset:2432
  ds_read_b64 v[114:115], v2 offset:2440
  ds_read_b128 v[116:119], v3 offset:608
  ds_read_b128 v[120:123], v3 offset:96
  ds_read_b64 v[124:125], v2 offset:384
  ds_read_b64 v[126:127], v2 offset:392
  v_mfma_f32_32x32x16_bf16 v[64:79], v[128:131], v[136:139], v[64:79]
  s_add_u32 m0, s89, 17408
  s_nop 0
  buffer_load_dwordx4 v195, s[24:27], s88 offen lds
  v_mfma_f32_32x32x16_bf16 v[80:95], v[140:143], v[136:139], v[80:95]
  s_waitcnt lgkmcnt(6)
  v_mfma_f32_32x32x16_bf16 v[80:95], v[96:99], v[100:103], v[80:95]
  ds_read_b64 v[128:129], v2 offset:2400
  ds_read_b64 v[130:131], v2 offset:2408
  ds_read_b128 v[132:135], v3 offset:3664
  ds_read_b128 v[136:139], v3 offset:3152
  ds_read_b64 v[140:141], v2 offset:352
  ds_read_b64 v[142:143], v2 offset:360
  v_mfma_f32_32x32x16_bf16 v[64:79], v[96:99], v[104:107], v[64:79]
  s_add_u32 m0, s89, 18432
  s_nop 0
  buffer_load_dwordx4 v196, s[24:27], s88 offen lds
  v_mfma_f32_32x32x16_bf16 v[80:95], v[108:111], v[104:107], v[80:95]
  s_waitcnt lgkmcnt(6)
  v_mfma_f32_32x32x16_bf16 v[80:95], v[112:115], v[116:119], v[80:95]
  ds_read_b64 v[96:97], v2 offset:2368
  ds_read_b64 v[98:99], v2 offset:2376
  ds_read_b128 v[100:103], v3 offset:592
  ds_read_b128 v[104:107], v3 offset:80
  ds_read_b64 v[108:109], v2 offset:320
  ds_read_b64 v[110:111], v2 offset:328
  v_mfma_f32_32x32x16_bf16 v[64:79], v[112:115], v[120:123], v[64:79]
  s_add_u32 m0, s89, 19456
  s_nop 0
  buffer_load_dwordx4 v197, s[24:27], s88 offen lds
  v_mfma_f32_32x32x16_bf16 v[80:95], v[124:127], v[120:123], v[80:95]
  s_waitcnt lgkmcnt(6)
  v_mfma_f32_32x32x16_bf16 v[80:95], v[128:131], v[132:135], v[80:95]
  ds_read_b64 v[112:113], v2 offset:2336
  ds_read_b64 v[114:115], v2 offset:2344
  ds_read_b128 v[116:119], v3 offset:3648
  ds_read_b128 v[120:123], v3 offset:3136
  ds_read_b64 v[124:125], v2 offset:288
  ds_read_b64 v[126:127], v2 offset:296
  v_mfma_f32_32x32x16_bf16 v[64:79], v[128:131], v[136:139], v[64:79]
  s_add_u32 m0, s89, 20480
  s_nop 0
  buffer_load_dwordx4 v198, s[24:27], s88 offen lds
  v_mfma_f32_32x32x16_bf16 v[80:95], v[140:143], v[136:139], v[80:95]
  s_waitcnt lgkmcnt(6)
  v_mfma_f32_32x32x16_bf16 v[80:95], v[96:99], v[100:103], v[80:95]
  ds_read_b64 v[128:129], v2 offset:2304
  ds_read_b64 v[130:131], v2 offset:2312
  ds_read_b128 v[132:135], v3 offset:576
  ds_read_b128 v[136:139], v3 offset:64
  ds_read_b64 v[140:141], v2 offset:256
  ds_read_b64 v[142:143], v2 offset:264
  v_mfma_f32_32x32x16_bf16 v[64:79], v[96:99], v[104:107], v[64:79]
  s_add_u32 s88, s88, 114688
  s_add_u32 m0, s89, 21504
  s_nop 0
  buffer_load_dwordx4 v192, s[24:27], s88 offen lds
  v_mfma_f32_32x32x16_bf16 v[80:95], v[108:111], v[104:107], v[80:95]
  s_waitcnt lgkmcnt(6)
  v_mfma_f32_32x32x16_bf16 v[80:95], v[112:115], v[116:119], v[80:95]
  ds_read_b64 v[96:97], v2 offset:2272
  ds_read_b64 v[98:99], v2 offset:2280
  ds_read_b128 v[100:103], v3 offset:3632
  ds_read_b128 v[104:107], v3 offset:3120
  ds_read_b64 v[108:109], v2 offset:224
  ds_read_b64 v[110:111], v2 offset:232
  v_mfma_f32_32x32x16_bf16 v[64:79], v[112:115], v[120:123], v[64:79]
  s_add_u32 m0, s89, 22528
  s_nop 0
  buffer_load_dwordx4 v193, s[24:27], s88 offen lds
  v_mfma_f32_32x32x16_bf16 v[80:95], v[124:127], v[120:123], v[80:95]
  s_waitcnt lgkmcnt(6)
  v_mfma_f32_32x32x16_bf16 v[80:95], v[128:131], v[132:135], v[80:95]
  ds_read_b64 v[112:113], v2 offset:2240
  ds_read_b64 v[114:115], v2 offset:2248
  ds_read_b128 v[116:119], v3 offset:560
  ds_read_b128 v[120:123], v3 offset:48
  ds_read_b64 v[124:125], v2 offset:192
  ds_read_b64 v[126:127], v2 offset:200
  v_mfma_f32_32x32x16_bf16 v[64:79], v[128:131], v[136:139], v[64:79]
  s_add_u32 m0, s89, 23552
  s_nop 0
  buffer_load_dwordx4 v194, s[24:27], s88 offen lds
  v_mfma_f32_32x32x16_bf16 v[80:95], v[140:143], v[136:139], v[80:95]
  s_waitcnt lgkmcnt(6)
  v_mfma_f32_32x32x16_bf16 v[80:95], v[96:99], v[100:103], v[80:95]
  ds_read_b64 v[128:129], v2 offset:2208
  ds_read_b64 v[130:131], v2 offset:2216
  ds_read_b128 v[132:135], v3 offset:3616
  ds_read_b128 v[136:139], v3 offset:3104
  ds_read_b64 v[140:141], v2 offset:160
  ds_read_b64 v[142:143], v2 offset:168
  v_mfma_f32_32x32x16_bf16 v[64:79], v[96:99], v[104:107], v[64:79]
  s_add_u32 m0, s89, 24576
  s_nop 0
  buffer_load_dwordx4 v195, s[24:27], s88 offen lds
  v_mfma_f32_32x32x16_bf16 v[80:95], v[108:111], v[104:107], v[80:95]
  s_waitcnt lgkmcnt(6)
  v_mfma_f32_32x32x16_bf16 v[80:95], v[112:115], v[116:119], v[80:95]
  ds_read_b64 v[96:97], v2 offset:2176
  ds_read_b64 v[98:99], v2 offset:2184
  ds_read_b128 v[100:103], v3 offset:544
  ds_read_b128 v[104:107], v3 offset:32
  ds_read_b64 v[108:109], v2 offset:128
  ds_read_b64 v[110:111], v2 offset:136
  v_mfma_f32_32x32x16_bf16 v[64:79], v[112:115], v[120:123], v[64:79]
  s_add_u32 m0, s89, 25600
  s_nop 0
  buffer_load_dwordx4 v196, s[24:27], s88 offen lds
  v_mfma_f32_32x32x16_bf16 v[80:95], v[124:127], v[120:123], v[80:95]
  s_waitcnt lgkmcnt(6)
  v_mfma_f32_32x32x16_bf16 v[80:95], v[128:131], v[132:135], v[80:95]
  ds_read_b64 v[112:113], v2 offset:2144
  ds_read_b64 v[114:115], v2 offset:2152
  ds_read_b128 v[116:119], v3 offset:3600
  ds_read_b128 v[120:123], v3 offset:3088
  ds_read_b64 v[124:125], v2 offset:96
  ds_read_b64 v[126:127], v2 offset:104
  v_mfma_f32_32x32x16_bf16 v[64:79], v[128:131], v[136:139], v[64:79]
  s_add_u32 m0, s89, 26624
  s_nop 0
  buffer_load_dwordx4 v197, s[24:27], s88 offen lds
  v_mfma_f32_32x32x16_bf16 v[80:95], v[140:143], v[136:139], v[80:95]
  s_waitcnt lgkmcnt(6)
  v_mfma_f32_32x32x16_bf16 v[80:95], v[96:99], v[100:103], v[80:95]
  ds_read_b64 v[128:129], v2 offset:2112
  ds_read_b64 v[130:131], v2 offset:2120
  ds_read_b128 v[132:135], v3 offset:528
  ds_read_b128 v[136:139], v3 offset:16
  ds_read_b64 v[140:141], v2 offset:64
  ds_read_b64 v[142:143], v2 offset:72
  v_mfma_f32_32x32x16_bf16 v[64:79], v[96:99], v[104:107], v[64:79]
  s_add_u32 m0, s89, 27648
  s_nop 0
  buffer_load_dwordx4 v198, s[24:27], s88 offen lds
  v_mfma_f32_32x32x16_bf16 v[80:95], v[108:111], v[104:107], v[80:95]
  s_waitcnt lgkmcnt(6)
  v_mfma_f32_32x32x16_bf16 v[80:95], v[112:115], v[116:119], v[80:95]
  ds_read_b64 v[96:97], v2 offset:2080
  ds_read_b64 v[98:99], v2 offset:2088
  ds_read_b128 v[100:103], v3 offset:3584
  ds_read_b128 v[104:107], v3 offset:3072
  ds_read_b64 v[108:109], v2 offset:32
  ds_read_b64 v[110:111], v2 offset:40
  v_mfma_f32_32x32x16_bf16 v[64:79], v[112:115], v[120:123], v[64:79]
  v_mfma_f32_32x32x16_bf16 v[80:95], v[124:127], v[120:123], v[80:95]
  s_waitcnt lgkmcnt(6)
  v_mfma_f32_32x32x16_bf16 v[80:95], v[128:131], v[132:135], v[80:95]
  ds_read_b64 v[112:113], v2 offset:2048
  ds_read_b64 v[114:115], v2 offset:2056
  ds_read_b128 v[116:119], v3 offset:512
  ds_read_b128 v[120:123], v3 offset:0
  ds_read_b64 v[124:125], v2 offset:0
  ds_read_b64 v[126:127], v2 offset:8
  v_mfma_f32_32x32x16_bf16 v[64:79], v[128:131], v[136:139], v[64:79]
  v_mfma_f32_32x32x16_bf16 v[80:95], v[140:143], v[136:139], v[80:95]
  s_waitcnt lgkmcnt(6)
  v_mfma_f32_32x32x16_bf16 v[80:95], v[96:99], v[100:103], v[80:95]
  v_mfma_f32_32x32x16_bf16 v[64:79], v[96:99], v[104:107], v[64:79]
  v_mfma_f32_32x32x16_bf16 v[80:95], v[108:111], v[104:107], v[80:95]
  s_waitcnt lgkmcnt(0)
  v_mfma_f32_32x32x16_bf16 v[80:95], v[112:115], v[116:119], v[80:95]
  v_mfma_f32_32x32x16_bf16 v[64:79], v[112:115], v[120:123], v[64:79]
  v_mfma_f32_32x32x16_bf16 v[80:95], v[124:127], v[120:123], v[80:95]
  s_lshl_b32 s59, s52, 2
  s_add_u32 s59, s59, 4096
  s_or_b32 s60, s98, s101
  v_mov_b32 v5, s60
  s_mov_b64 exec, 1
  buffer_store_dword v5, off, s[32:35], s59 sc1
  s_mov_b64 exec, -1
  v_mov_b32 v146, s98
  v_mov_b32 v147, s99
  v_mov_b32 v150, s98
  v_mov_b32 v151, s99
  v_mov_b32 v154, s98
  v_mov_b32 v155, s99
  v_mov_b32 v158, s98
  v_mov_b32 v159, s99
  s_barrier
  s_lshl_b32 s57, s6, 13
  s_add_u32 s57, s57, 114688
  v_lshlrev_b32 v2, 4, v1
  v_add_u32 v3, s57, v2
  ds_write_b128 v3, v[64:67] offset:0
  ds_write_b128 v3, v[68:71] offset:1024
  ds_write_b128 v3, v[72:75] offset:2048
  ds_write_b128 v3, v[76:79] offset:3072
  ds_write_b128 v3, v[80:83] offset:4096
  ds_write_b128 v3, v[84:87] offset:5120
  ds_write_b128 v3, v[88:91] offset:6144
  ds_write_b128 v3, v[92:95] offset:7168
  s_and_b32 s58, s6, 1
  s_lshr_b32 s59, s6, 1
  v_and_b32 v4, 31, v1
  v_lshlrev_b32 v4, 4, v4
  v_lshrrev_b32 v5, 5, v1
  v_lshl_add_u32 v4, v5, 3, v4
  s_mul_i32 s60, s58, 3072
  s_lshl_b32 s61, s59, 9
  s_add_u32 s60, s60, s61
  s_add_u32 s60, s60, 148480
  v_add_u32 v4, s60, v4
  ds_read_b64 v[96:97], v4 offset:0
  ds_read_b64 v[98:99], v4 offset:1536
  ds_read_b64 v[100:101], v4 offset:6144
  ds_read_b64 v[102:103], v4 offset:7680
  v_lshrrev_b32 v4, 3, v1
  v_lshlrev_b32 v4, 16, v4
  v_and_b32 v8, 7, v1
  v_lshl_add_u32 v4, v8, 4, v4
  s_lshl_b32 s60, s59, 21
  s_lshl_b32 s57, s58, 15
  s_add_u32 s60, s60, s57
  s_lshl_b32 s57, s52, 7
  s_add_u32 s60, s60, s57
  s_add_u32 s76, s60, 6291456
  s_add_u32 s77, s76, 0x80000
  s_add_u32 s78, s76, 0x100000
  s_add_u32 s79, s76, 0x180000
  s_waitcnt lgkmcnt(0)
  s_barrier
  s_lshl_b32 s57, s6, 11
  s_add_u32 s57, s57, 114688
  v_add_u32 v3, s57, v2
  ds_read_b128 v[104:107], v3 offset:0
  ds_read_b128 v[108:111], v3 offset:1024
  ds_read_b128 v[112:115], v3 offset:8192
  ds_read_b128 v[116:119], v3 offset:9216
  ds_read_b128 v[120:123], v3 offset:16384
  ds_read_b128 v[124:127], v3 offset:17408
  ds_read_b128 v[128:131], v3 offset:24576
  ds_read_b128 v[132:135], v3 offset:25600
  s_lshl_b32 s61, s53, 16
  s_and_b32 s57, s53, s92
  v_lshlrev_b32 v64, 16, v96
  v_and_b32 v65, s92, v96
  v_lshlrev_b32 v66, 16, v97
  v_and_b32 v67, s92, v97
  v_lshlrev_b32 v68, 16, v98
  v_and_b32 v69, s92, v98
  v_lshlrev_b32 v70, 16, v99
  v_and_b32 v71, s92, v99
  v_lshlrev_b32 v72, 16, v100
  v_and_b32 v73, s92, v100
  v_lshlrev_b32 v74, 16, v101
  v_and_b32 v75, s92, v101
  v_lshlrev_b32 v76, 16, v102
  v_and_b32 v77, s92, v102
  v_lshlrev_b32 v78, 16, v103
  v_and_b32 v79, s92, v103
  v_mov_b32 v10, s61
  v_mov_b32 v12, s57
  s_lshl_b32 s62, s6, 11
  s_add_u32 s62, s62, 147456
  v_and_b32 v6, 31, v1
  v_lshlrev_b32 v6, 5, v6
  v_lshl_add_u32 v6, v5, 4, v6
  v_add_u32 v6, s62, v6
  s_waitcnt lgkmcnt(0)
  v_pk_add_f32 v[104:105], v[104:105], v[120:121]
  v_pk_add_f32 v[106:107], v[106:107], v[122:123]
  v_pk_add_f32 v[108:109], v[108:109], v[124:125]
  v_pk_add_f32 v[110:111], v[110:111], v[126:127]
  v_pk_fma_f32 v[104:105], v[64:65], v[10:11], v[104:105] op_sel_hi:[1,0,1]
  v_pk_fma_f32 v[106:107], v[66:67], v[10:11], v[106:107] op_sel_hi:[1,0,1]
  v_pk_fma_f32 v[108:109], v[68:69], v[10:11], v[108:109] op_sel_hi:[1,0,1]
  v_pk_fma_f32 v[110:111], v[70:71], v[10:11], v[110:111] op_sel_hi:[1,0,1]
  v_pk_add_f32 v[112:113], v[112:113], v[128:129]
  v_pk_add_f32 v[114:115], v[114:115], v[130:131]
  v_pk_add_f32 v[116:117], v[116:117], v[132:133]
  v_pk_add_f32 v[118:119], v[118:119], v[134:135]
  v_pk_fma_f32 v[112:113], v[72:73], v[12:13], v[112:113] op_sel_hi:[1,0,1]
  v_pk_fma_f32 v[114:115], v[74:75], v[12:13], v[114:115] op_sel_hi:[1,0,1]
  v_pk_fma_f32 v[116:117], v[76:77], v[12:13], v[116:117] op_sel_hi:[1,0,1]
  v_pk_fma_f32 v[118:119], v[78:79], v[12:13], v[118:119] op_sel_hi:[1,0,1]
  v_cvt_pk_bf16_f32 v80, v104, v112
  v_cvt_pk_bf16_f32 v81, v105, v113
  v_cvt_pk_bf16_f32 v82, v106, v114
  v_cvt_pk_bf16_f32 v83, v107, v115
  v_cvt_pk_bf16_f32 v84, v108, v116
  v_cvt_pk_bf16_f32 v85, v109, v117
  v_cvt_pk_bf16_f32 v86, v110, v118
  v_cvt_pk_bf16_f32 v87, v111, v119
  ds_write_b128 v6, v[80:83]
  ds_write_b128 v6, v[84:87] offset:1024
  v_bfe_u32 v7, v1, 2, 1
  v_lshlrev_b32 v7, 10, v7
  v_lshrrev_b32 v8, 3, v1
  v_lshl_add_u32 v7, v8, 5, v7
  v_and_b32 v8, 3, v1
  v_lshl_add_u32 v7, v8, 3, v7
  v_add_u32 v7, s62, v7
  ds_read_b64 v[144:145], v7 offset:0
  ds_read_b64 v[148:149], v7 offset:256
  ds_read_b64 v[152:153], v7 offset:512
  ds_read_b64 v[156:157], v7 offset:768
  s_waitcnt lgkmcnt(0)
  buffer_store_dwordx4 v[144:147], v4, s[32:35], s76 offen sc1
  buffer_store_dwordx4 v[148:151], v4, s[32:35], s77 offen sc1
  buffer_store_dwordx4 v[152:155], v4, s[32:35], s78 offen sc1
  buffer_store_dwordx4 v[156:159], v4, s[32:35], s79 offen sc1
  s_barrier
  v_bfe_u32 v5, v1, 4, 2
  v_lshlrev_b32 v5, 1, v5
  v_and_b32 v6, 7, v1
  v_xor_b32 v5, v5, v6
  v_lshlrev_b32 v5, 4, v5
  v_lshrrev_b32 v6, 3, v1
  v_lshl_add_u32 v5, v6, 10, v5
  s_lshl_b32 s59, s96, 7
  v_add_u32 v248, s59, v5
  s_mul_i32 s73, s86, 458752
  s_mul_i32 s74, s6, 12288
  s_add_u32 s74, s74, 114688
  v_lshrrev_b32 v5, 2, v1
  v_lshlrev_b32 v5, 7, v5
  v_bfe_u32 v6, v1, 1, 1
  v_lshl_add_u32 v5, v6, 4, v5
  v_and_b32 v6, 1, v1
  v_lshl_add_u32 v5, v6, 3, v5
  v_add_u32 v5, s74, v5
  v_bfe_u32 v6, v1, 3, 2
  v_xor_b32 v7, 0, v6
  v_lshl_add_u32 v249, v7, 5, v5
  v_xor_b32 v7, 1, v6
  v_lshl_add_u32 v250, v7, 5, v5
  v_xor_b32 v7, 2, v6
  v_lshl_add_u32 v251, v7, 5, v5
  v_xor_b32 v7, 3, v6
  v_lshl_add_u32 v252, v7, 5, v5
  s_add_u32 m0, s74, 0
  s_add_u32 s75, s73, 0
  buffer_load_dwordx4 v248, s[28:31], s75 offen lds
  s_add_u32 m0, s74, 1024
  s_add_u32 s75, s73, 8192
  buffer_load_dwordx4 v248, s[28:31], s75 offen lds
  s_add_u32 m0, s74, 2048
  s_add_u32 s75, s73, 16384
  buffer_load_dwordx4 v248, s[28:31], s75 offen lds
  s_add_u32 m0, s74, 3072
  s_add_u32 s75, s73, 24576
  buffer_load_dwordx4 v248, s[28:31], s75 offen lds
  s_add_u32 m0, s74, 4096
  s_add_u32 s75, s73, 32768
  buffer_load_dwordx4 v248, s[28:31], s75 offen lds
  s_add_u32 m0, s74, 5120
  s_add_u32 s75, s73, 40960
  buffer_load_dwordx4 v248, s[28:31], s75 offen lds
  s_add_u32 m0, s74, 6144
  s_add_u32 s75, s73, 49152
  buffer_load_dwordx4 v248, s[28:31], s75 offen lds
  s_add_u32 m0, s74, 7168
  s_add_u32 s75, s73, 57344
  buffer_load_dwordx4 v248, s[28:31], s75 offen lds
  s_add_u32 m0, s74, 8192
  s_add_u32 s75, s73, 65536
  buffer_load_dwordx4 v248, s[28:31], s75 offen lds
  s_add_u32 m0, s74, 9216
  s_add_u32 s75, s73, 73728
  buffer_load_dwordx4 v248, s[28:31], s75 offen lds
  s_add_u32 m0, s74, 10240
  s_add_u32 s75, s73, 81920
  buffer_load_dwordx4 v248, s[28:31], s75 offen lds
  s_add_u32 m0, s74, 11264
  s_add_u32 s75, s73, 90112
  buffer_load_dwordx4 v248, s[28:31], s75 offen lds
  s_waitcnt vmcnt(8)
  ds_read_b64_tr_b16 a[0:1], v249 offset:0
  ds_read_b64_tr_b16 a[2:3], v249 offset:2048
  ds_read_b64_tr_b16 a[4:5], v250 offset:0
  ds_read_b64_tr_b16 a[6:7], v250 offset:2048
  ds_read_b64_tr_b16 a[8:9], v251 offset:0
  ds_read_b64_tr_b16 a[10:11], v251 offset:2048
  ds_read_b64_tr_b16 a[12:13], v252 offset:0
  ds_read_b64_tr_b16 a[14:15], v252 offset:2048
  s_waitcnt lgkmcnt(0)
  s_add_u32 m0, s74, 0
  s_add_u32 s75, s73, 114688
  buffer_load_dwordx4 v248, s[28:31], s75 offen lds
  s_add_u32 m0, s74, 1024
  s_add_u32 s75, s73, 122880
  buffer_load_dwordx4 v248, s[28:31], s75 offen lds
  s_add_u32 m0, s74, 2048
  s_add_u32 s75, s73, 131072
  buffer_load_dwordx4 v248, s[28:31], s75 offen lds
  s_add_u32 m0, s74, 3072
  s_add_u32 s75, s73, 139264
  buffer_load_dwordx4 v248, s[28:31], s75 offen lds
  s_waitcnt vmcnt(8)
  ds_read_b64_tr_b16 a[16:17], v249 offset:4096
  ds_read_b64_tr_b16 a[18:19], v249 offset:6144
  ds_read_b64_tr_b16 a[20:21], v250 offset:4096
  ds_read_b64_tr_b16 a[22:23], v250 offset:6144
  ds_read_b64_tr_b16 a[24:25], v251 offset:4096
  ds_read_b64_tr_b16 a[26:27], v251 offset:6144
  ds_read_b64_tr_b16 a[28:29], v252 offset:4096
  ds_read_b64_tr_b16 a[30:31], v252 offset:6144
  s_waitcnt lgkmcnt(0)
  s_add_u32 m0, s74, 4096
  s_add_u32 s75, s73, 147456
  buffer_load_dwordx4 v248, s[28:31], s75 offen lds
  s_add_u32 m0, s74, 5120
  s_add_u32 s75, s73, 155648
  buffer_load_dwordx4 v248, s[28:31], s75 offen lds
  s_add_u32 m0, s74, 6144
  s_add_u32 s75, s73, 163840
  buffer_load_dwordx4 v248, s[28:31], s75 offen lds
  s_add_u32 m0, s74, 7168
  s_add_u32 s75, s73, 172032
  buffer_load_dwordx4 v248, s[28:31], s75 offen lds
  s_waitcnt vmcnt(8)
  ds_read_b64_tr_b16 a[32:33], v249 offset:8192
  ds_read_b64_tr_b16 a[34:35], v249 offset:10240
  ds_read_b64_tr_b16 a[36:37], v250 offset:8192
  ds_read_b64_tr_b16 a[38:39], v250 offset:10240
  ds_read_b64_tr_b16 a[40:41], v251 offset:8192
  ds_read_b64_tr_b16 a[42:43], v251 offset:10240
  ds_read_b64_tr_b16 a[44:45], v252 offset:8192
  ds_read_b64_tr_b16 a[46:47], v252 offset:10240
  s_waitcnt vmcnt(4)
  ds_read_b64_tr_b16 a[48:49], v249 offset:0
  ds_read_b64_tr_b16 a[50:51], v249 offset:2048
  ds_read_b64_tr_b16 a[52:53], v250 offset:0
  ds_read_b64_tr_b16 a[54:55], v250 offset:2048
  ds_read_b64_tr_b16 a[56:57], v251 offset:0
  ds_read_b64_tr_b16 a[58:59], v251 offset:2048
  ds_read_b64_tr_b16 a[60:61], v252 offset:0
  ds_read_b64_tr_b16 a[62:63], v252 offset:2048
  s_waitcnt vmcnt(0)
  ds_read_b64_tr_b16 a[64:65], v249 offset:4096
  ds_read_b64_tr_b16 a[66:67], v249 offset:6144
  ds_read_b64_tr_b16 a[68:69], v250 offset:4096
  ds_read_b64_tr_b16 a[70:71], v250 offset:6144
  ds_read_b64_tr_b16 a[72:73], v251 offset:4096
  ds_read_b64_tr_b16 a[74:75], v251 offset:6144
  ds_read_b64_tr_b16 a[76:77], v252 offset:4096
  ds_read_b64_tr_b16 a[78:79], v252 offset:6144
  s_lshl_b32 s62, s4, 5
  s_lshl_b32 s57, s62, 2
  s_add_u32 s57, s57, 4096
  v_min_u32 v2, 31, v1
  v_lshlrev_b32 v2, 2, v2
  s_mov_b32 s56, 262144
L_poll_10:
  buffer_load_dword v3, v2, s[32:35], s57 offen sc1
  s_waitcnt vmcnt(0)
  v_and_b32 v4, -16, v3
  v_cmp_ne_u32 vcc, s98, v4
  s_cbranch_vccz L_polld_11
  s_sub_u32 s56, s56, 1
  s_cbranch_scc1 L_polt_12
  s_sleep 1
  s_branch L_poll_10
L_polt_12:
L_polld_11:
  v_and_b32 v4, 15, v3
  v_cmp_ne_u32 vcc, s101, v4
  s_nop 0
  s_cmp_eq_u64 vcc, 0
  s_cselect_b32 s100, 1, 0
  s_lshl_b32 s57, s4, 18
  s_add_u32 s54, s57, 14680064
  s_add_u32 s85, s57, 18874368
  s_mov_b32 s84, 10485760
  s_mov_b32 s72, 20971520
  s_lshl_b32 s57, s4, 19
  s_add_u32 s57, s57, 2097152
  s_add_u32 s58, s57, 0x40000
  s_cmp_eq_u32 s100, 1
  s_cmov_b32 s54, s57
  s_cmov_b32 s85, s58
  s_cmov_b32 s84, 6291456
  s_waitcnt vmcnt(0) lgkmcnt(0)
  s_barrier
  v_lshrrev_b32 v2, 2, v1
  v_lshlrev_b32 v2, 7, v2
  v_and_b32 v3, 3, v1
  v_lshl_add_u32 v2, v3, 4, v2
  s_lshr_b32 s57, s52, 1
  s_lshl_b32 s57, s57, 15
  s_and_b32 s58, s52, 1
  s_lshl_b32 s58, s58, 6
  s_add_u32 s57, s57, s58
  s_add_u32 s57, s57, 6291456
  s_lshl_b32 s58, s6, 13
  s_add_u32 s57, s57, s58
  s_add_u32 s59, s57, 4096
  v_and_b32 v3, 3, v1
  v_lshlrev_b32 v3, 11, v3
  v_bfe_u32 v4, v1, 2, 4
  v_lshl_add_u32 v3, v4, 2, v3
  s_lshl_b32 s58, s6, 8
  s_add_u32 s58, s58, 155648
  v_add_u32 v3, s58, v3
  v_add_u32 v76, 64, v3
  v_add_u32 v77, 0x80, v3
  v_add_u32 v78, 0xc0, v3
  v_lshrrev_b32 v75, 5, v0
  v_lshlrev_b32 v75, 10, v75
  v_bfe_u32 v5, v0, 2, 3
  v_lshl_add_u32 v75, v5, 7, v75
  v_and_b32 v5, 3, v0
  v_lshl_add_u32 v75, v5, 3, v75
  v_add_u32 v75, 155648, v75
  v_bfe_u32 v72, v0, 2, 3
  v_lshlrev_b32 v73, 7, v72
  v_lshlrev_b32 v72, 11, v72
  v_and_b32 v74, 3, v0
  v_lshl_add_u32 v72, v74, 8, v72
  v_lshl_add_u32 v73, v74, 4, v73
  v_lshrrev_b32 v74, 5, v0
  v_lshl_add_u32 v72, v74, 4, v72
  v_lshl_add_u32 v73, v74, 10, v73
  s_lshr_b32 s76, s5, 1
  s_lshl_b32 s76, s76, 14
  s_and_b32 s77, s5, 1
  s_lshl_b32 s77, s77, 7
  s_add_u32 s76, s76, s77
  s_add_u32 s76, s76, s54
  s_lshl_b32 s77, s5, 13
  s_add_u32 s77, s77, s85
  v_accvgpr_read_b32 v48, a224
  v_accvgpr_read_b32 v49, a225
  v_accvgpr_read_b32 v50, a226
  v_accvgpr_read_b32 v51, a227
  v_accvgpr_read_b32 v52, a228
  v_accvgpr_read_b32 v53, a229
  v_accvgpr_read_b32 v54, a230
  v_accvgpr_read_b32 v55, a231
  v_lshlrev_b32 v16, 16, v48
  v_and_b32 v17, s92, v48
  v_lshlrev_b32 v18, 16, v49
  v_and_b32 v19, s92, v49
  v_lshlrev_b32 v20, 16, v50
  v_and_b32 v21, s92, v50
  v_lshlrev_b32 v22, 16, v51
  v_and_b32 v23, s92, v51
  v_lshlrev_b32 v24, 16, v52
  v_and_b32 v25, s92, v52
  v_lshlrev_b32 v26, 16, v53
  v_and_b32 v27, s92, v53
  v_lshlrev_b32 v28, 16, v54
  v_and_b32 v29, s92, v54
  v_lshlrev_b32 v30, 16, v55
  v_and_b32 v31, s92, v55
  s_mov_b32 s56, 262144
  buffer_load_dwordx4 v[80:83], v2, s[32:35], s57 offen offset:0 sc1
  buffer_load_dwordx4 v[84:87], v2, s[32:35], s57 offen offset:2048 sc1
  buffer_load_dwordx4 v[88:91], v2, s[32:35], s59 offen offset:0 sc1
  buffer_load_dwordx4 v[92:95], v2, s[32:35], s59 offen offset:2048 sc1
  s_waitcnt vmcnt(3)
L_tq_13:
  v_cmp_ne_u64 vcc, s[98:99], v[82:83]
  s_cbranch_vccz L_tqn_14
  s_sub_u32 s56, s56, 1
  s_cbranch_scc1 L_tqt_15
  s_sleep 2
  buffer_load_dwordx4 v[80:83], v2, s[32:35], s57 offen offset:0 sc1
  s_waitcnt vmcnt(0)
  s_branch L_tq_13
L_tqt_15:
L_tqn_14:
  s_waitcnt vmcnt(2)
L_tq_16:
  v_cmp_ne_u64 vcc, s[98:99], v[86:87]
  s_cbranch_vccz L_tqn_17
  s_sub_u32 s56, s56, 1
  s_cbranch_scc1 L_tqt_18
  s_sleep 2
  buffer_load_dwordx4 v[84:87], v2, s[32:35], s57 offen offset:2048 sc1
  s_waitcnt vmcnt(0)
  s_branch L_tq_16
L_tqt_18:
L_tqn_17:
  s_waitcnt vmcnt(1)
L_tq_19:
  v_cmp_ne_u64 vcc, s[98:99], v[90:91]
  s_cbranch_vccz L_tqn_20
  s_sub_u32 s56, s56, 1
  s_cbranch_scc1 L_tqt_21
  s_sleep 2
  buffer_load_dwordx4 v[88:91], v2, s[32:35], s59 offen offset:0 sc1
  s_waitcnt vmcnt(0)
  s_branch L_tq_19
L_tqt_21:
L_tqn_20:
  s_waitcnt vmcnt(0)
L_tq_22:
  v_cmp_ne_u64 vcc, s[98:99], v[94:95]
  s_cbranch_vccz L_tqn_23
  s_sub_u32 s56, s56, 1
  s_cbranch_scc1 L_tqt_24
  s_sleep 2
  buffer_load_dwordx4 v[92:95], v2, s[32:35], s59 offen offset:2048 sc1
  s_waitcnt vmcnt(0)
  s_branch L_tq_22
L_tqt_24:
L_tqn_23:
  ds_write2st64_b32 v3, v80, v81 offset0:0 offset1:4
  ds_write2st64_b32 v76, v84, v85 offset0:0 offset1:4
  ds_write2st64_b32 v77, v88, v89 offset0:0 offset1:4
  ds_write2st64_b32 v78, v92, v93 offset0:0 offset1:4
  s_lshl_b32 s57, s4, 4
  s_lshl_b32 s58, s93, 3
  s_add_u32 s57, s57, s58
  s_lshl_b32 s58, s6, 1
  s_add_u32 s57, s57, s58
  s_mul_i32 s57, s57, 57344
  s_add_u32 s57, s57, 20971520
  s_lshr_b32 s58, s94, 1
  s_mul_i32 s58, s58, 7168
  s_add_u32 s57, s57, s58
  s_and_b32 s59, s94, 1
  s_mul_i32 s59, s59, 3072
  v_and_b32 v5, 31, v1
  v_lshlrev_b32 v6, 7, v5
  v_add_u32 v7, s59, v6
  v_add_u32 v6, 3072, v6
  v_cmp_gt_u32 vcc, 24, v5
  s_nop 1
  v_cndmask_b32 v6, v6, v7, vcc
  v_lshrrev_b32 v5, 5, v1
  v_mul_u32_u24 v5, 57344, v5
  v_add_u32 v6, v6, v5
  buffer_load_dword v254, v6, s[32:35], s57 offen
  s_waitcnt lgkmcnt(0)
  s_barrier
  ds_read_b64 v[64:65], v75 offset:0
  ds_read_b64 v[66:67], v75 offset:32
  ds_read_b64 v[68:69], v75 offset:64
  ds_read_b64 v[70:71], v75 offset:96
  s_waitcnt lgkmcnt(0)
  v_lshlrev_b32 v32, 16, v64
  v_and_b32 v33, s92, v64
  v_accvgpr_write_b32 a232, v64
  v_lshlrev_b32 v34, 16, v65
  v_and_b32 v35, s92, v65
  v_accvgpr_write_b32 a233, v65
  v_lshlrev_b32 v36, 16, v66
  v_and_b32 v37, s92, v66
  v_accvgpr_write_b32 a234, v66
  v_lshlrev_b32 v38, 16, v67
  v_and_b32 v39, s92, v67
  v_accvgpr_write_b32 a235, v67
  v_lshlrev_b32 v40, 16, v68
  v_and_b32 v41, s92, v68
  v_accvgpr_write_b32 a236, v68
  v_lshlrev_b32 v42, 16, v69
  v_and_b32 v43, s92, v69
  v_accvgpr_write_b32 a237, v69
  v_lshlrev_b32 v44, 16, v70
  v_and_b32 v45, s92, v70
  v_accvgpr_write_b32 a238, v70
  v_lshlrev_b32 v46, 16, v71
  v_and_b32 v47, s92, v71
  v_accvgpr_write_b32 a239, v71
  v_pk_add_f32 v[8:9], v[16:17], v[18:19]
  v_pk_mul_f32 v[10:11], v[16:17], v[16:17]
  v_pk_add_f32 v[12:13], v[20:21], v[22:23]
  v_pk_mul_f32 v[14:15], v[18:19], v[18:19]
  v_pk_add_f32 v[8:9], v[8:9], v[24:25]
  v_pk_fma_f32 v[10:11], v[20:21], v[20:21], v[10:11]
  v_pk_add_f32 v[12:13], v[12:13], v[26:27]
  v_pk_fma_f32 v[14:15], v[22:23], v[22:23], v[14:15]
  v_pk_add_f32 v[8:9], v[8:9], v[28:29]
  v_pk_fma_f32 v[10:11], v[24:25], v[24:25], v[10:11]
  v_pk_add_f32 v[12:13], v[12:13], v[30:31]
  v_pk_fma_f32 v[14:15], v[26:27], v[26:27], v[14:15]
  v_pk_fma_f32 v[10:11], v[28:29], v[28:29], v[10:11]
  v_pk_fma_f32 v[14:15], v[30:31], v[30:31], v[14:15]
  v_pk_add_f32 v[8:9], v[8:9], v[12:13]
  v_pk_add_f32 v[10:11], v[10:11], v[14:15]
  v_add_f32 v4, v8, v9
  v_add_f32 v5, v10, v11
  s_nop 0
  v_add_f32_dpp v4, v4, v4 row_ror:8 row_mask:0xf bank_mask:0xf
  v_add_f32_dpp v5, v5, v5 row_ror:8 row_mask:0xf bank_mask:0xf
  s_nop 0
  v_add_f32_dpp v4, v4, v4 row_ror:4 row_mask:0xf bank_mask:0xf
  v_add_f32_dpp v5, v5, v5 row_ror:4 row_mask:0xf bank_mask:0xf
  s_nop 0
  v_add_f32_dpp v4, v4, v4 row_ror:2 row_mask:0xf bank_mask:0xf
  v_add_f32_dpp v5, v5, v5 row_ror:2 row_mask:0xf bank_mask:0xf
  s_nop 0
  v_add_f32_dpp v4, v4, v4 row_ror:1 row_mask:0xf bank_mask:0xf
  v_add_f32_dpp v5, v5, v5 row_ror:1 row_mask:0xf bank_mask:0xf
  v_mov_b32 v6, v4
  v_mov_b32 v7, v5
  s_nop 0
  v_permlane16_swap_b32 v4, v6
  v_permlane16_swap_b32 v5, v7
  v_add_f32 v4, v4, v6
  v_add_f32 v5, v5, v7
  v_mul_f32 v4, 0x3b000000, v4
  v_mul_f32 v5, 0x3b000000, v5
  v_fma_f32 v5, -v4, v4, v5
  v_max_f32 v5, 0, v5
  v_add_f32 v5, s97, v5
  v_rsq_f32 v6, v5
  s_nop 0
  v_mul_f32 v8, v4, v6
  v_pk_fma_f32 v[48:49], v[16:17], v[6:7], v[8:9] op_sel_hi:[1,0,0] neg_lo:[0,0,1] neg_hi:[0,0,1]
  v_pk_fma_f32 v[50:51], v[18:19], v[6:7], v[8:9] op_sel_hi:[1,0,0] neg_lo:[0,0,1] neg_hi:[0,0,1]
  v_pk_fma_f32 v[52:53], v[20:21], v[6:7], v[8:9] op_sel_hi:[1,0,0] neg_lo:[0,0,1] neg_hi:[0,0,1]
  v_pk_fma_f32 v[54:55], v[22:23], v[6:7], v[8:9] op_sel_hi:[1,0,0] neg_lo:[0,0,1] neg_hi:[0,0,1]
  v_pk_fma_f32 v[56:57], v[24:25], v[6:7], v[8:9] op_sel_hi:[1,0,0] neg_lo:[0,0,1] neg_hi:[0,0,1]
  v_pk_fma_f32 v[58:59], v[26:27], v[6:7], v[8:9] op_sel_hi:[1,0,0] neg_lo:[0,0,1] neg_hi:[0,0,1]
  v_pk_fma_f32 v[60:61], v[28:29], v[6:7], v[8:9] op_sel_hi:[1,0,0] neg_lo:[0,0,1] neg_hi:[0,0,1]
  v_pk_fma_f32 v[62:63], v[30:31], v[6:7], v[8:9] op_sel_hi:[1,0,0] neg_lo:[0,0,1] neg_hi:[0,0,1]
  v_pk_fma_f32 v[16:17], v[48:49], v[32:33], v[16:17]
  v_pk_fma_f32 v[18:19], v[50:51], v[34:35], v[18:19]
  v_pk_fma_f32 v[20:21], v[52:53], v[36:37], v[20:21]
  v_pk_fma_f32 v[22:23], v[54:55], v[38:39], v[22:23]
  v_pk_fma_f32 v[24:25], v[56:57], v[40:41], v[24:25]
  v_pk_fma_f32 v[26:27], v[58:59], v[42:43], v[26:27]
  v_pk_fma_f32 v[28:29], v[60:61], v[44:45], v[28:29]
  v_pk_fma_f32 v[30:31], v[62:63], v[46:47], v[30:31]
  v_cvt_pk_bf16_f32 v48, v16, v17
  v_cvt_pk_bf16_f32 v49, v18, v19
  v_cvt_pk_bf16_f32 v50, v20, v21
  v_cvt_pk_bf16_f32 v51, v22, v23
  v_cvt_pk_bf16_f32 v52, v24, v25
  v_cvt_pk_bf16_f32 v53, v26, v27
  v_cvt_pk_bf16_f32 v54, v28, v29
  v_cvt_pk_bf16_f32 v55, v30, v31
  v_accvgpr_write_b32 a224, v48
  v_accvgpr_write_b32 a225, v49
  v_accvgpr_write_b32 a226, v50
  v_accvgpr_write_b32 a227, v51
  v_accvgpr_write_b32 a228, v52
  v_accvgpr_write_b32 a229, v53
  v_accvgpr_write_b32 a230, v54
  v_accvgpr_write_b32 a231, v55
  v_pk_add_f32 v[8:9], v[16:17], v[18:19]
  v_pk_mul_f32 v[10:11], v[16:17], v[16:17]
  v_pk_add_f32 v[12:13], v[20:21], v[22:23]
  v_pk_mul_f32 v[14:15], v[18:19], v[18:19]
  v_pk_add_f32 v[8:9], v[8:9], v[24:25]
  v_pk_fma_f32 v[10:11], v[20:21], v[20:21], v[10:11]
  v_pk_add_f32 v[12:13], v[12:13], v[26:27]
  v_pk_fma_f32 v[14:15], v[22:23], v[22:23], v[14:15]
  v_pk_add_f32 v[8:9], v[8:9], v[28:29]
  v_pk_fma_f32 v[10:11], v[24:25], v[24:25], v[10:11]
  v_pk_add_f32 v[12:13], v[12:13], v[30:31]
  v_pk_fma_f32 v[14:15], v[26:27], v[26:27], v[14:15]
  v_pk_fma_f32 v[10:11], v[28:29], v[28:29], v[10:11]
  v_pk_fma_f32 v[14:15], v[30:31], v[30:31], v[14:15]
  v_pk_add_f32 v[8:9], v[8:9], v[12:13]
  v_pk_add_f32 v[10:11], v[10:11], v[14:15]
  v_add_f32 v4, v8, v9
  v_add_f32 v5, v10, v11
  s_nop 0
  v_add_f32_dpp v4, v4, v4 row_ror:8 row_mask:0xf bank_mask:0xf
  v_add_f32_dpp v5, v5, v5 row_ror:8 row_mask:0xf bank_mask:0xf
  s_nop 0
  v_add_f32_dpp v4, v4, v4 row_ror:4 row_mask:0xf bank_mask:0xf
  v_add_f32_dpp v5, v5, v5 row_ror:4 row_mask:0xf bank_mask:0xf
  s_nop 0
  v_add_f32_dpp v4, v4, v4 row_ror:2 row_mask:0xf bank_mask:0xf
  v_add_f32_dpp v5, v5, v5 row_ror:2 row_mask:0xf bank_mask:0xf
  s_nop 0
  v_add_f32_dpp v4, v4, v4 row_ror:1 row_mask:0xf bank_mask:0xf
  v_add_f32_dpp v5, v5, v5 row_ror:1 row_mask:0xf bank_mask:0xf
  v_mov_b32 v6, v4
  v_mov_b32 v7, v5
  s_nop 0
  v_permlane16_swap_b32 v4, v6
  v_permlane16_swap_b32 v5, v7
  v_add_f32 v4, v4, v6
  v_add_f32 v5, v5, v7
  v_mul_f32 v4, 0x3b000000, v4
  v_mul_f32 v5, 0x3b000000, v5
  v_fma_f32 v5, -v4, v4, v5
  v_max_f32 v5, 0, v5
  v_add_f32 v6, s97, v5
  v_rsq_f32 v7, v6
  v_rcp_f32 v6, v6
  s_nop 0
  v_mul_f32 v6, v5, v6
  v_add_f32 v6, s97, v6
  v_rsq_f32 v6, v6
  s_nop 0
  v_mul_f32 v6, v7, v6
  v_mul_f32 v8, v4, v6
  v_pk_fma_f32 v[16:17], v[16:17], v[6:7], v[8:9] op_sel_hi:[1,0,0] neg_lo:[0,0,1] neg_hi:[0,0,1]
  v_pk_fma_f32 v[18:19], v[18:19], v[6:7], v[8:9] op_sel_hi:[1,0,0] neg_lo:[0,0,1] neg_hi:[0,0,1]
  v_pk_fma_f32 v[20:21], v[20:21], v[6:7], v[8:9] op_sel_hi:[1,0,0] neg_lo:[0,0,1] neg_hi:[0,0,1]
  v_pk_fma_f32 v[22:23], v[22:23], v[6:7], v[8:9] op_sel_hi:[1,0,0] neg_lo:[0,0,1] neg_hi:[0,0,1]
  v_pk_fma_f32 v[24:25], v[24:25], v[6:7], v[8:9] op_sel_hi:[1,0,0] neg_lo:[0,0,1] neg_hi:[0,0,1]
  v_pk_fma_f32 v[26:27], v[26:27], v[6:7], v[8:9] op_sel_hi:[1,0,0] neg_lo:[0,0,1] neg_hi:[0,0,1]
  v_pk_fma_f32 v[28:29], v[28:29], v[6:7], v[8:9] op_sel_hi:[1,0,0] neg_lo:[0,0,1] neg_hi:[0,0,1]
  v_pk_fma_f32 v[30:31], v[30:31], v[6:7], v[8:9] op_sel_hi:[1,0,0] neg_lo:[0,0,1] neg_hi:[0,0,1]
  v_cvt_pk_bf16_f32 v56, v16, v17
  v_cvt_pk_bf16_f32 v57, v18, v19
  v_cvt_pk_bf16_f32 v58, v20, v21
  v_cvt_pk_bf16_f32 v59, v22, v23
  v_cvt_pk_bf16_f32 v60, v24, v25
  v_cvt_pk_bf16_f32 v61, v26, v27
  v_cvt_pk_bf16_f32 v62, v28, v29
  v_cvt_pk_bf16_f32 v63, v30, v31
  buffer_store_dwordx4 v[56:59], v72, s[32:35], s76 offen
  buffer_store_dwordx4 v[60:63], v72, s[32:35], s76 offen offset:1024
  s_or_b32 s57, s52, s6
  s_cmp_lg_u32 s57, 0
  s_cbranch_scc1 L_ep_25
  v_mov_b32 v2, s98
  s_mov_b64 exec, 1
  buffer_store_dword v2, off, s[32:35], 0 sc1
  s_mov_b64 exec, -1
L_ep_25:
  s_waitcnt vmcnt(0) lgkmcnt(0)
  s_cmp_eq_u32 s100, 1
  s_cbranch_scc1 L_sigp_27
  buffer_wbl2 sc1
  s_waitcnt vmcnt(0)
L_sigp_27:
  s_barrier
  s_cmp_lg_u32 s6, 0
  s_cbranch_scc1 L_sig_26
  s_lshl_b32 s57, s52, 2
  s_add_u32 s57, s57, 5120
  v_mov_b32 v2, s98
  s_mov_b64 exec, 1
  s_cmp_eq_u32 s100, 1
  s_cbranch_scc1 L_stp_28
  buffer_store_dword v2, off, s[32:35], s57 sc1
  s_branch L_std_29
L_stp_28:
  buffer_store_dword v2, off, s[32:35], s57
L_std_29:
  s_mov_b64 exec, -1
L_sig_26:
  s_xor_b32 s99, s99, 0x33333333
  v_lshrrev_b32 v2, 4, v1
  v_lshlrev_b32 v2, 3, v2
  s_mul_i32 s57, s94, 224
  buffer_load_dwordx2 v[64:65], v2, s[44:47], s57 offen offset:0
  buffer_load_dwordx2 v[66:67], v2, s[44:47], s57 offen offset:32
  buffer_load_dwordx2 v[68:69], v2, s[44:47], s57 offen offset:64
  buffer_load_dwordx2 v[70:71], v2, s[44:47], s57 offen offset:96
  buffer_load_dwordx2 v[72:73], v2, s[44:47], s57 offen offset:128
  buffer_load_dwordx2 v[74:75], v2, s[44:47], s57 offen offset:160
  buffer_load_dwordx2 v[76:77], v2, s[44:47], s57 offen offset:192
  s_add_u32 m0, s74, 8192
  s_add_u32 s75, s73, 180224
  buffer_load_dwordx4 v248, s[28:31], s75 offen lds
  s_add_u32 m0, s74, 9216
  s_add_u32 s75, s73, 188416
  buffer_load_dwordx4 v248, s[28:31], s75 offen lds
  s_add_u32 m0, s74, 10240
  s_add_u32 s75, s73, 196608
  buffer_load_dwordx4 v248, s[28:31], s75 offen lds
  s_add_u32 m0, s74, 11264
  s_add_u32 s75, s73, 204800
  buffer_load_dwordx4 v248, s[28:31], s75 offen lds
  s_add_u32 m0, s74, 0
  s_add_u32 s75, s73, 98304
  buffer_load_dwordx4 v248, s[28:31], s75 offen lds
  s_add_u32 m0, s74, 1024
  s_add_u32 s75, s73, 106496
  buffer_load_dwordx4 v248, s[28:31], s75 offen lds
  s_add_u32 m0, s74, 2048
  s_add_u32 s75, s73, 212992
  buffer_load_dwordx4 v248, s[28:31], s75 offen lds
  s_add_u32 m0, s74, 3072
  s_add_u32 s75, s73, 221184
  buffer_load_dwordx4 v248, s[28:31], s75 offen lds
  s_waitcnt vmcnt(4)
  ds_read_b64_tr_b16 a[80:81], v249 offset:8192
  ds_read_b64_tr_b16 a[82:83], v249 offset:10240
  ds_read_b64_tr_b16 a[84:85], v250 offset:8192
  ds_read_b64_tr_b16 a[86:87], v250 offset:10240
  ds_read_b64_tr_b16 a[88:89], v251 offset:8192
  ds_read_b64_tr_b16 a[90:91], v251 offset:10240
  ds_read_b64_tr_b16 a[92:93], v252 offset:8192
  ds_read_b64_tr_b16 a[94:95], v252 offset:10240
  s_waitcnt vmcnt(0)
  ds_read_b64_tr_b16 a[96:97], v249 offset:0
  ds_read_b64_tr_b16 a[98:99], v249 offset:2048
  ds_read_b64_tr_b16 a[100:101], v250 offset:0
  ds_read_b64_tr_b16 a[102:103], v250 offset:2048
  ds_read_b64_tr_b16 a[104:105], v251 offset:0
  ds_read_b64_tr_b16 a[106:107], v251 offset:2048
  ds_read_b64_tr_b16 a[108:109], v252 offset:0
  ds_read_b64_tr_b16 a[110:111], v252 offset:2048
  v_lshlrev_b32 v8, 16, v64
  v_and_b32 v9, s92, v64
  v_lshlrev_b32 v10, 16, v65
  v_and_b32 v11, s92, v65
  v_lshlrev_b32 v12, 16, v64
  v_and_b32 v13, s92, v64
  v_lshlrev_b32 v14, 16, v65
  v_and_b32 v15, s92, v65
  v_lshlrev_b32 v16, 16, v66
  v_and_b32 v17, s92, v66
  v_lshlrev_b32 v18, 16, v67
  v_and_b32 v19, s92, v67
  v_lshlrev_b32 v20, 16, v66
  v_and_b32 v21, s92, v66
  v_lshlrev_b32 v22, 16, v67
  v_and_b32 v23, s92, v67
  v_lshlrev_b32 v24, 16, v68
  v_and_b32 v25, s92, v68
  v_lshlrev_b32 v26, 16, v69
  v_and_b32 v27, s92, v69
  v_lshlrev_b32 v28, 16, v68
  v_and_b32 v29, s92, v68
  v_lshlrev_b32 v30, 16, v69
  v_and_b32 v31, s92, v69
  v_lshlrev_b32 v32, 16, v70
  v_and_b32 v33, s92, v70
  v_lshlrev_b32 v34, 16, v71
  v_and_b32 v35, s92, v71
  v_lshlrev_b32 v36, 16, v70
  v_and_b32 v37, s92, v70
  v_lshlrev_b32 v38, 16, v71
  v_and_b32 v39, s92, v71
  v_lshlrev_b32 v40, 16, v72
  v_and_b32 v41, s92, v72
  v_lshlrev_b32 v42, 16, v73
  v_and_b32 v43, s92, v73
  v_lshlrev_b32 v44, 16, v72
  v_and_b32 v45, s92, v72
  v_lshlrev_b32 v46, 16, v73
  v_and_b32 v47, s92, v73
  v_lshlrev_b32 v48, 16, v74
  v_and_b32 v49, s92, v74
  v_lshlrev_b32 v50, 16, v75
  v_and_b32 v51, s92, v75
  v_lshlrev_b32 v52, 16, v74
  v_and_b32 v53, s92, v74
  v_lshlrev_b32 v54, 16, v75
  v_and_b32 v55, s92, v75
  v_lshlrev_b32 v56, 16, v76
  v_and_b32 v57, s92, v76
  v_lshlrev_b32 v58, 16, v77
  v_and_b32 v59, s92, v77
  v_lshlrev_b32 v60, 16, v76
  v_and_b32 v61, s92, v76
  v_lshlrev_b32 v62, 16, v77
  v_and_b32 v63, s92, v77
  s_lshl_b32 s62, s4, 5
  s_lshl_b32 s61, s93, 4
  s_add_u32 s62, s62, s61
  s_lshl_b32 s61, s6, 2
  s_add_u32 s62, s62, s61
  s_lshl_b32 s57, s62, 2
  s_add_u32 s57, s57, 5120
  v_min_u32 v2, 3, v1
  v_lshlrev_b32 v2, 2, v2
  s_mov_b32 s56, 262144
L_poll_30:
  buffer_load_dword v3, v2, s[32:35], s57 offen sc1
  s_waitcnt vmcnt(0)
  v_cmp_ne_u32 vcc, s98, v3
  s_cbranch_vccz L_polld_31
  s_sub_u32 s56, s56, 1
  s_cbranch_scc1 L_polt_32
  s_sleep 1
  s_branch L_poll_30
L_polt_32:
L_polld_31:
  s_cmp_eq_u32 s100, 1
  s_cbranch_scc1 L_acq_33
  buffer_inv sc1
  s_waitcnt vmcnt(0)
L_acq_33:
  v_lshlrev_b32 v2, 4, v1
  s_lshl_b32 s57, s93, 17
  s_lshl_b32 s58, s6, 15
  s_add_u32 s57, s57, s58
  s_add_u32 s57, s57, s54
  s_add_u32 s58, s57, 16384
  buffer_load_dwordx4 v[120:123], v2, s[32:35], s57 offen offset:0 sc1
  buffer_load_dwordx4 v[124:127], v2, s[32:35], s58 offen offset:0 sc1
  buffer_load_dwordx4 v[128:131], v2, s[32:35], s57 offen offset:1024 sc1
  buffer_load_dwordx4 v[132:135], v2, s[32:35], s58 offen offset:1024 sc1
  buffer_load_dwordx4 v[136:139], v2, s[32:35], s57 offen offset:2048 sc1
  buffer_load_dwordx4 v[140:143], v2, s[32:35], s58 offen offset:2048 sc1
  buffer_load_dwordx4 v[144:147], v2, s[32:35], s57 offen offset:3072 sc1
  buffer_load_dwordx4 v[148:151], v2, s[32:35], s58 offen offset:3072 sc1
  s_add_u32 s57, s57, 4096
  s_add_u32 s58, s58, 4096
  v_lshrrev_b32 v3, 2, v1
  v_mul_u32_u24 v3, 224, v3
  v_and_b32 v4, 3, v1
  v_lshl_add_u32 v3, v4, 3, v3
  v_add_u32 v4, 57344, v3
  ds_read_b64_tr_b16 v[64:65], v3 offset:0
  ds_read_b64_tr_b16 v[66:67], v3 offset:3584
  ds_read_b64_tr_b16 v[68:69], v3 offset:32
  ds_read_b64_tr_b16 v[70:71], v3 offset:3616
  ds_read_b64_tr_b16 v[72:73], v3 offset:64
  ds_read_b64_tr_b16 v[74:75], v3 offset:3648
  ds_read_b64_tr_b16 v[76:77], v3 offset:96
  ds_read_b64_tr_b16 v[78:79], v3 offset:3680
  ds_read_b64_tr_b16 v[80:81], v3 offset:128
  ds_read_b64_tr_b16 v[82:83], v3 offset:3712
  ds_read_b64_tr_b16 v[84:85], v3 offset:160
  ds_read_b64_tr_b16 v[86:87], v3 offset:3744
  ds_read_b64_tr_b16 v[88:89], v3 offset:192
  ds_read_b64_tr_b16 v[90:91], v3 offset:3776
  s_waitcnt vmcnt(6) lgkmcnt(8)
  v_mfma_f32_16x16x32_bf16 v[8:11], v[64:67], v[120:123], v[8:11]
  ds_read_b64_tr_b16 v[92:93], v3 offset:7168
  v_mfma_f32_16x16x32_bf16 v[12:15], v[64:67], v[124:127], v[12:15]
  ds_read_b64_tr_b16 v[94:95], v3 offset:10752
  s_add_u32 m0, s74, 4096
  s_add_u32 s75, s73, 229376
  buffer_load_dwordx4 v248, s[28:31], s75 offen lds
  v_mfma_f32_16x16x32_bf16 v[16:19], v[68:71], v[120:123], v[16:19]
  ds_read_b64_tr_b16 v[96:97], v3 offset:7200
  buffer_load_dwordx4 v[152:155], v2, s[32:35], s57 offen offset:0 sc1
  v_mfma_f32_16x16x32_bf16 v[20:23], v[68:71], v[124:127], v[20:23]
  ds_read_b64_tr_b16 v[98:99], v3 offset:10784
  buffer_load_dwordx4 v[156:159], v2, s[32:35], s58 offen offset:0 sc1
  v_mfma_f32_16x16x32_bf16 v[24:27], v[72:75], v[120:123], v[24:27]
  ds_read_b64_tr_b16 v[100:101], v3 offset:7232
  v_mfma_f32_16x16x32_bf16 v[28:31], v[72:75], v[124:127], v[28:31]
  ds_read_b64_tr_b16 v[102:103], v3 offset:10816
  s_add_u32 m0, s74, 5120
  s_add_u32 s75, s73, 237568
  buffer_load_dwordx4 v248, s[28:31], s75 offen lds
  s_waitcnt lgkmcnt(10)
  v_mfma_f32_16x16x32_bf16 v[32:35], v[76:79], v[120:123], v[32:35]
  ds_read_b64_tr_b16 v[104:105], v3 offset:7264
  v_mfma_f32_16x16x32_bf16 v[36:39], v[76:79], v[124:127], v[36:39]
  ds_read_b64_tr_b16 v[106:107], v3 offset:10848
  v_mfma_f32_16x16x32_bf16 v[40:43], v[80:83], v[120:123], v[40:43]
  ds_read_b64_tr_b16 v[108:109], v3 offset:7296
  v_mfma_f32_16x16x32_bf16 v[44:47], v[80:83], v[124:127], v[44:47]
  ds_read_b64_tr_b16 v[110:111], v3 offset:10880
  s_add_u32 m0, s74, 6144
  s_add_u32 s75, s73, 245760
  buffer_load_dwordx4 v248, s[28:31], s75 offen lds
  s_waitcnt lgkmcnt(10)
  v_mfma_f32_16x16x32_bf16 v[48:51], v[84:87], v[120:123], v[48:51]
  ds_read_b64_tr_b16 v[112:113], v3 offset:7328
  v_mfma_f32_16x16x32_bf16 v[52:55], v[84:87], v[124:127], v[52:55]
  ds_read_b64_tr_b16 v[114:115], v3 offset:10912
  v_mfma_f32_16x16x32_bf16 v[56:59], v[88:91], v[120:123], v[56:59]
  ds_read_b64_tr_b16 v[116:117], v3 offset:7360
  v_mfma_f32_16x16x32_bf16 v[60:63], v[88:91], v[124:127], v[60:63]
  ds_read_b64_tr_b16 v[118:119], v3 offset:10944
  s_add_u32 m0, s74, 7168
  s_add_u32 s75, s73, 253952
  buffer_load_dwordx4 v248, s[28:31], s75 offen lds
  s_waitcnt vmcnt(10) lgkmcnt(8)
  v_mfma_f32_16x16x32_bf16 v[8:11], v[92:95], v[128:131], v[8:11]
  ds_read_b64_tr_b16 v[64:65], v3 offset:14336
  v_mfma_f32_16x16x32_bf16 v[12:15], v[92:95], v[132:135], v[12:15]
  ds_read_b64_tr_b16 v[66:67], v3 offset:17920
  s_add_u32 m0, s74, 8192
  s_add_u32 s75, s73, 262144
  buffer_load_dwordx4 v248, s[28:31], s75 offen lds
  v_mfma_f32_16x16x32_bf16 v[16:19], v[96:99], v[128:131], v[16:19]
  ds_read_b64_tr_b16 v[68:69], v3 offset:14368
  buffer_load_dwordx4 v[160:163], v2, s[32:35], s57 offen offset:1024 sc1
  v_mfma_f32_16x16x32_bf16 v[20:23], v[96:99], v[132:135], v[20:23]
  ds_read_b64_tr_b16 v[70:71], v3 offset:17952
  buffer_load_dwordx4 v[164:167], v2, s[32:35], s58 offen offset:1024 sc1
  v_mfma_f32_16x16x32_bf16 v[24:27], v[100:103], v[128:131], v[24:27]
  ds_read_b64_tr_b16 v[72:73], v3 offset:14400
  v_mfma_f32_16x16x32_bf16 v[28:31], v[100:103], v[132:135], v[28:31]
  ds_read_b64_tr_b16 v[74:75], v3 offset:17984
  s_add_u32 m0, s74, 9216
  s_add_u32 s75, s73, 270336
  buffer_load_dwordx4 v248, s[28:31], s75 offen lds
  s_waitcnt lgkmcnt(10)
  v_mfma_f32_16x16x32_bf16 v[32:35], v[104:107], v[128:131], v[32:35]
  ds_read_b64_tr_b16 v[76:77], v3 offset:14432
  v_mfma_f32_16x16x32_bf16 v[36:39], v[104:107], v[132:135], v[36:39]
  ds_read_b64_tr_b16 v[78:79], v3 offset:18016
  v_mfma_f32_16x16x32_bf16 v[40:43], v[108:111], v[128:131], v[40:43]
  ds_read_b64_tr_b16 v[80:81], v3 offset:14464
  v_mfma_f32_16x16x32_bf16 v[44:47], v[108:111], v[132:135], v[44:47]
  ds_read_b64_tr_b16 v[82:83], v3 offset:18048
  s_add_u32 m0, s74, 10240
  s_add_u32 s75, s73, 278528
  buffer_load_dwordx4 v248, s[28:31], s75 offen lds
  s_waitcnt lgkmcnt(10)
  v_mfma_f32_16x16x32_bf16 v[48:51], v[112:115], v[128:131], v[48:51]
  ds_read_b64_tr_b16 v[84:85], v3 offset:14496
  v_mfma_f32_16x16x32_bf16 v[52:55], v[112:115], v[132:135], v[52:55]
  ds_read_b64_tr_b16 v[86:87], v3 offset:18080
  v_mfma_f32_16x16x32_bf16 v[56:59], v[116:119], v[128:131], v[56:59]
  ds_read_b64_tr_b16 v[88:89], v3 offset:14528
  v_mfma_f32_16x16x32_bf16 v[60:63], v[116:119], v[132:135], v[60:63]
  ds_read_b64_tr_b16 v[90:91], v3 offset:18112
  s_add_u32 m0, s74, 11264
  s_add_u32 s75, s73, 286720
  buffer_load_dwordx4 v248, s[28:31], s75 offen lds
  s_waitcnt vmcnt(14) lgkmcnt(8)
  v_mfma_f32_16x16x32_bf16 v[8:11], v[64:67], v[136:139], v[8:11]
  ds_read_b64_tr_b16 v[92:93], v3 offset:21504
  v_mfma_f32_16x16x32_bf16 v[12:15], v[64:67], v[140:143], v[12:15]
  ds_read_b64_tr_b16 v[94:95], v3 offset:25088
  s_add_u32 m0, s74, 0
  s_add_u32 s75, s73, 294912
  buffer_load_dwordx4 v248, s[28:31], s75 offen lds
  v_mfma_f32_16x16x32_bf16 v[16:19], v[68:71], v[136:139], v[16:19]
  ds_read_b64_tr_b16 v[96:97], v3 offset:21536
  buffer_load_dwordx4 v[168:171], v2, s[32:35], s57 offen offset:2048 sc1
  v_mfma_f32_16x16x32_bf16 v[20:23], v[68:71], v[140:143], v[20:23]
  ds_read_b64_tr_b16 v[98:99], v3 offset:25120
  buffer_load_dwordx4 v[172:175], v2, s[32:35], s58 offen offset:2048 sc1
  v_mfma_f32_16x16x32_bf16 v[24:27], v[72:75], v[136:139], v[24:27]
  ds_read_b64_tr_b16 v[100:101], v3 offset:21568
  v_mfma_f32_16x16x32_bf16 v[28:31], v[72:75], v[140:143], v[28:31]
  ds_read_b64_tr_b16 v[102:103], v3 offset:25152
  s_add_u32 m0, s74, 1024
  s_add_u32 s75, s73, 303104
  buffer_load_dwordx4 v248, s[28:31], s75 offen lds
  s_waitcnt lgkmcnt(10)
  v_mfma_f32_16x16x32_bf16 v[32:35], v[76:79], v[136:139], v[32:35]
  ds_read_b64_tr_b16 v[104:105], v3 offset:21600
  v_mfma_f32_16x16x32_bf16 v[36:39], v[76:79], v[140:143], v[36:39]
  ds_read_b64_tr_b16 v[106:107], v3 offset:25184
  v_mfma_f32_16x16x32_bf16 v[40:43], v[80:83], v[136:139], v[40:43]
  ds_read_b64_tr_b16 v[108:109], v3 offset:21632
  v_mfma_f32_16x16x32_bf16 v[44:47], v[80:83], v[140:143], v[44:47]
  ds_read_b64_tr_b16 v[110:111], v3 offset:25216
  s_add_u32 m0, s74, 2048
  s_add_u32 s75, s73, 311296
  buffer_load_dwordx4 v248, s[28:31], s75 offen lds
  s_waitcnt lgkmcnt(10)
  v_mfma_f32_16x16x32_bf16 v[48:51], v[84:87], v[136:139], v[48:51]
  ds_read_b64_tr_b16 v[112:113], v3 offset:21664
  v_mfma_f32_16x16x32_bf16 v[52:55], v[84:87], v[140:143], v[52:55]
  ds_read_b64_tr_b16 v[114:115], v3 offset:25248
  v_mfma_f32_16x16x32_bf16 v[56:59], v[88:91], v[136:139], v[56:59]
  ds_read_b64_tr_b16 v[116:117], v3 offset:21696
  v_mfma_f32_16x16x32_bf16 v[60:63], v[88:91], v[140:143], v[60:63]
  ds_read_b64_tr_b16 v[118:119], v3 offset:25280
  s_add_u32 m0, s74, 3072
  s_add_u32 s75, s73, 319488
  buffer_load_dwordx4 v248, s[28:31], s75 offen lds
  s_waitcnt vmcnt(18) lgkmcnt(8)
  v_mfma_f32_16x16x32_bf16 v[8:11], v[92:95], v[144:147], v[8:11]
  ds_read_b64_tr_b16 v[64:65], v3 offset:28672
  v_mfma_f32_16x16x32_bf16 v[12:15], v[92:95], v[148:151], v[12:15]
  ds_read_b64_tr_b16 v[66:67], v3 offset:32256
  v_mfma_f32_16x16x32_bf16 v[16:19], v[96:99], v[144:147], v[16:19]
  ds_read_b64_tr_b16 v[68:69], v3 offset:28704
  buffer_load_dwordx4 v[176:179], v2, s[32:35], s57 offen offset:3072 sc1
  v_mfma_f32_16x16x32_bf16 v[20:23], v[96:99], v[148:151], v[20:23]
  ds_read_b64_tr_b16 v[70:71], v3 offset:32288
  buffer_load_dwordx4 v[180:183], v2, s[32:35], s58 offen offset:3072 sc1
  s_add_u32 s57, s57, 4096
  s_add_u32 s58, s58, 4096
  v_mfma_f32_16x16x32_bf16 v[24:27], v[100:103], v[144:147], v[24:27]
  ds_read_b64_tr_b16 v[72:73], v3 offset:28736
  v_mfma_f32_16x16x32_bf16 v[28:31], v[100:103], v[148:151], v[28:31]
  ds_read_b64_tr_b16 v[74:75], v3 offset:32320
  s_waitcnt vmcnt(14)
  s_waitcnt lgkmcnt(10)
  v_mfma_f32_16x16x32_bf16 v[32:35], v[104:107], v[144:147], v[32:35]
  ds_read_b64_tr_b16 v[76:77], v3 offset:28768
  v_mfma_f32_16x16x32_bf16 v[36:39], v[104:107], v[148:151], v[36:39]
  ds_read_b64_tr_b16 v[78:79], v3 offset:32352
  ds_read_b64_tr_b16 a[112:113], v249 offset:4096
  ds_read_b64_tr_b16 a[114:115], v249 offset:6144
  v_mfma_f32_16x16x32_bf16 v[40:43], v[108:111], v[144:147], v[40:43]
  ds_read_b64_tr_b16 v[80:81], v3 offset:28800
  v_mfma_f32_16x16x32_bf16 v[44:47], v[108:111], v[148:151], v[44:47]
  ds_read_b64_tr_b16 v[82:83], v3 offset:32384
  ds_read_b64_tr_b16 a[116:117], v250 offset:4096
  ds_read_b64_tr_b16 a[118:119], v250 offset:6144
  s_waitcnt lgkmcnt(14)
  v_mfma_f32_16x16x32_bf16 v[48:51], v[112:115], v[144:147], v[48:51]
  ds_read_b64_tr_b16 v[84:85], v3 offset:28832
  v_mfma_f32_16x16x32_bf16 v[52:55], v[112:115], v[148:151], v[52:55]
  ds_read_b64_tr_b16 v[86:87], v3 offset:32416
  ds_read_b64_tr_b16 a[120:121], v251 offset:4096
  ds_read_b64_tr_b16 a[122:123], v251 offset:6144
  v_mfma_f32_16x16x32_bf16 v[56:59], v[116:119], v[144:147], v[56:59]
  ds_read_b64_tr_b16 v[88:89], v3 offset:28864
  v_mfma_f32_16x16x32_bf16 v[60:63], v[116:119], v[148:151], v[60:63]
  ds_read_b64_tr_b16 v[90:91], v3 offset:32448
  ds_read_b64_tr_b16 a[124:125], v252 offset:4096
  ds_read_b64_tr_b16 a[126:127], v252 offset:6144
  s_waitcnt lgkmcnt(15)
  v_mfma_f32_16x16x32_bf16 v[8:11], v[64:67], v[152:155], v[8:11]
  ds_read_b64_tr_b16 v[92:93], v3 offset:35840
  v_mfma_f32_16x16x32_bf16 v[12:15], v[64:67], v[156:159], v[12:15]
  ds_read_b64_tr_b16 v[94:95], v3 offset:39424
  s_waitcnt lgkmcnt(2)
  s_add_u32 m0, s74, 4096
  s_add_u32 s75, s73, 344064
  buffer_load_dwordx4 v248, s[28:31], s75 offen lds
  v_mfma_f32_16x16x32_bf16 v[16:19], v[68:71], v[152:155], v[16:19]
  ds_read_b64_tr_b16 v[96:97], v3 offset:35872
  buffer_load_dwordx4 v[184:187], v2, s[32:35], s57 offen offset:0 sc1
  v_mfma_f32_16x16x32_bf16 v[20:23], v[68:71], v[156:159], v[20:23]
  ds_read_b64_tr_b16 v[98:99], v3 offset:39456
  buffer_load_dwordx4 v[188:191], v2, s[32:35], s58 offen offset:0 sc1
  v_mfma_f32_16x16x32_bf16 v[24:27], v[72:75], v[152:155], v[24:27]
  ds_read_b64_tr_b16 v[100:101], v3 offset:35904
  v_mfma_f32_16x16x32_bf16 v[28:31], v[72:75], v[156:159], v[28:31]
  ds_read_b64_tr_b16 v[102:103], v3 offset:39488
  s_add_u32 m0, s74, 5120
  s_add_u32 s75, s73, 352256
  buffer_load_dwordx4 v248, s[28:31], s75 offen lds
  s_waitcnt vmcnt(12)
  v_mfma_f32_16x16x32_bf16 v[32:35], v[76:79], v[152:155], v[32:35]
  ds_read_b64_tr_b16 v[104:105], v3 offset:35936
  v_mfma_f32_16x16x32_bf16 v[36:39], v[76:79], v[156:159], v[36:39]
  ds_read_b64_tr_b16 v[106:107], v3 offset:39520
  ds_read_b64_tr_b16 a[128:129], v249 offset:8192
  ds_read_b64_tr_b16 a[130:131], v249 offset:10240
  v_mfma_f32_16x16x32_bf16 v[40:43], v[80:83], v[152:155], v[40:43]
  ds_read_b64_tr_b16 v[108:109], v3 offset:35968
  v_mfma_f32_16x16x32_bf16 v[44:47], v[80:83], v[156:159], v[44:47]
  ds_read_b64_tr_b16 v[110:111], v3 offset:39552
  s_add_u32 m0, s74, 6144
  s_add_u32 s75, s73, 360448
  buffer_load_dwordx4 v248, s[28:31], s75 offen lds
  ds_read_b64_tr_b16 a[132:133], v250 offset:8192
  ds_read_b64_tr_b16 a[134:135], v250 offset:10240
  v_mfma_f32_16x16x32_bf16 v[48:51], v[84:87], v[152:155], v[48:51]
  ds_read_b64_tr_b16 v[112:113], v3 offset:36000
  v_mfma_f32_16x16x32_bf16 v[52:55], v[84:87], v[156:159], v[52:55]
  ds_read_b64_tr_b16 v[114:115], v3 offset:39584
  ds_read_b64_tr_b16 a[136:137], v251 offset:8192
  ds_read_b64_tr_b16 a[138:139], v251 offset:10240
  v_mfma_f32_16x16x32_bf16 v[56:59], v[88:91], v[152:155], v[56:59]
  ds_read_b64_tr_b16 v[116:117], v3 offset:36032
  v_mfma_f32_16x16x32_bf16 v[60:63], v[88:91], v[156:159], v[60:63]
  ds_read_b64_tr_b16 v[118:119], v3 offset:39616
  s_add_u32 m0, s74, 7168
  s_add_u32 s75, s73, 368640
  buffer_load_dwordx4 v248, s[28:31], s75 offen lds
  ds_read_b64_tr_b16 a[140:141], v252 offset:8192
  ds_read_b64_tr_b16 a[142:143], v252 offset:10240
  s_waitcnt lgkmcnt(15)
  v_mfma_f32_16x16x32_bf16 v[8:11], v[92:95], v[160:163], v[8:11]
  ds_read_b64_tr_b16 v[64:65], v3 offset:43008
  v_mfma_f32_16x16x32_bf16 v[12:15], v[92:95], v[164:167], v[12:15]
  ds_read_b64_tr_b16 v[66:67], v3 offset:46592
  s_waitcnt lgkmcnt(2)
  s_add_u32 m0, s74, 8192
  s_add_u32 s75, s73, 376832
  buffer_load_dwordx4 v248, s[28:31], s75 offen lds
  v_mfma_f32_16x16x32_bf16 v[16:19], v[96:99], v[160:163], v[16:19]
  ds_read_b64_tr_b16 v[68:69], v3 offset:43040
  buffer_load_dwordx4 v[192:195], v2, s[32:35], s57 offen offset:1024 sc1
  v_mfma_f32_16x16x32_bf16 v[20:23], v[96:99], v[164:167], v[20:23]
  ds_read_b64_tr_b16 v[70:71], v3 offset:46624
  buffer_load_dwordx4 v[196:199], v2, s[32:35], s58 offen offset:1024 sc1
  v_mfma_f32_16x16x32_bf16 v[24:27], v[100:103], v[160:163], v[24:27]
  ds_read_b64_tr_b16 v[72:73], v3 offset:43072
  v_mfma_f32_16x16x32_bf16 v[28:31], v[100:103], v[164:167], v[28:31]
  ds_read_b64_tr_b16 v[74:75], v3 offset:46656
  s_add_u32 m0, s74, 9216
  s_add_u32 s75, s73, 385024
  buffer_load_dwordx4 v248, s[28:31], s75 offen lds
  s_waitcnt vmcnt(12)
  v_mfma_f32_16x16x32_bf16 v[32:35], v[104:107], v[160:163], v[32:35]
  ds_read_b64_tr_b16 v[76:77], v3 offset:43104
  v_mfma_f32_16x16x32_bf16 v[36:39], v[104:107], v[164:167], v[36:39]
  ds_read_b64_tr_b16 v[78:79], v3 offset:46688
  ds_read_b64_tr_b16 a[144:145], v249 offset:0
  ds_read_b64_tr_b16 a[146:147], v249 offset:2048
  v_mfma_f32_16x16x32_bf16 v[40:43], v[108:111], v[160:163], v[40:43]
  ds_read_b64_tr_b16 v[80:81], v3 offset:43136
  v_mfma_f32_16x16x32_bf16 v[44:47], v[108:111], v[164:167], v[44:47]
  ds_read_b64_tr_b16 v[82:83], v3 offset:46720
  s_add_u32 m0, s74, 10240
  s_add_u32 s75, s73, 393216
  buffer_load_dwordx4 v248, s[28:31], s75 offen lds
  ds_read_b64_tr_b16 a[148:149], v250 offset:0
  ds_read_b64_tr_b16 a[150:151], v250 offset:2048
  v_mfma_f32_16x16x32_bf16 v[48:51], v[112:115], v[160:163], v[48:51]
  ds_read_b64_tr_b16 v[84:85], v3 offset:43168
  v_mfma_f32_16x16x32_bf16 v[52:55], v[112:115], v[164:167], v[52:55]
  ds_read_b64_tr_b16 v[86:87], v3 offset:46752
  ds_read_b64_tr_b16 a[152:153], v251 offset:0
  ds_read_b64_tr_b16 a[154:155], v251 offset:2048
  v_mfma_f32_16x16x32_bf16 v[56:59], v[116:119], v[160:163], v[56:59]
  ds_read_b64_tr_b16 v[88:89], v3 offset:43200
  v_mfma_f32_16x16x32_bf16 v[60:63], v[116:119], v[164:167], v[60:63]
  ds_read_b64_tr_b16 v[90:91], v3 offset:46784
  s_add_u32 m0, s74, 11264
  s_add_u32 s75, s73, 401408
  buffer_load_dwordx4 v248, s[28:31], s75 offen lds
  ds_read_b64_tr_b16 a[156:157], v252 offset:0
  ds_read_b64_tr_b16 a[158:159], v252 offset:2048
  s_waitcnt lgkmcnt(15)
  v_mfma_f32_16x16x32_bf16 v[8:11], v[64:67], v[168:171], v[8:11]
  ds_read_b64_tr_b16 v[92:93], v3 offset:50176
  v_mfma_f32_16x16x32_bf16 v[12:15], v[64:67], v[172:175], v[12:15]
  ds_read_b64_tr_b16 v[94:95], v3 offset:53760
  s_waitcnt lgkmcnt(2)
  s_add_u32 m0, s74, 0
  s_add_u32 s75, s73, 409600
  buffer_load_dwordx4 v248, s[28:31], s75 offen lds
  v_mfma_f32_16x16x32_bf16 v[16:19], v[68:71], v[168:171], v[16:19]
  ds_read_b64_tr_b16 v[96:97], v3 offset:50208
  buffer_load_dwordx4 v[200:203], v2, s[32:35], s57 offen offset:2048 sc1
  v_mfma_f32_16x16x32_bf16 v[20:23], v[68:71], v[172:175], v[20:23]
  ds_read_b64_tr_b16 v[98:99], v3 offset:53792
  buffer_load_dwordx4 v[204:207], v2, s[32:35], s58 offen offset:2048 sc1
  v_mfma_f32_16x16x32_bf16 v[24:27], v[72:75], v[168:171], v[24:27]
  ds_read_b64_tr_b16 v[100:101], v3 offset:50240
  v_mfma_f32_16x16x32_bf16 v[28:31], v[72:75], v[172:175], v[28:31]
  ds_read_b64_tr_b16 v[102:103], v3 offset:53824
  s_add_u32 m0, s74, 1024
  s_add_u32 s75, s73, 417792
  buffer_load_dwordx4 v248, s[28:31], s75 offen lds
  v_mfma_f32_16x16x32_bf16 v[32:35], v[76:79], v[168:171], v[32:35]
  ds_read_b64_tr_b16 v[104:105], v3 offset:50272
  v_mfma_f32_16x16x32_bf16 v[36:39], v[76:79], v[172:175], v[36:39]
  ds_read_b64_tr_b16 v[106:107], v3 offset:53856
  v_mfma_f32_16x16x32_bf16 v[40:43], v[80:83], v[168:171], v[40:43]
  ds_read_b64_tr_b16 v[108:109], v3 offset:50304
  v_mfma_f32_16x16x32_bf16 v[44:47], v[80:83], v[172:175], v[44:47]
  ds_read_b64_tr_b16 v[110:111], v3 offset:53888
  s_add_u32 m0, s74, 2048
  s_add_u32 s75, s73, 425984
  buffer_load_dwordx4 v248, s[28:31], s75 offen lds
  v_mfma_f32_16x16x32_bf16 v[48:51], v[84:87], v[168:171], v[48:51]
  ds_read_b64_tr_b16 v[112:113], v3 offset:50336
  v_mfma_f32_16x16x32_bf16 v[52:55], v[84:87], v[172:175], v[52:55]
  ds_read_b64_tr_b16 v[114:115], v3 offset:53920
  v_mfma_f32_16x16x32_bf16 v[56:59], v[88:91], v[168:171], v[56:59]
  ds_read_b64_tr_b16 v[116:117], v3 offset:50368
  v_mfma_f32_16x16x32_bf16 v[60:63], v[88:91], v[172:175], v[60:63]
  ds_read_b64_tr_b16 v[118:119], v3 offset:53952
  s_add_u32 m0, s74, 3072
  s_add_u32 s75, s73, 434176
  buffer_load_dwordx4 v248, s[28:31], s75 offen lds
  s_waitcnt vmcnt(18) lgkmcnt(8)
  v_mfma_f32_16x16x32_bf16 v[8:11], v[92:95], v[176:179], v[8:11]
  ds_read_b64_tr_b16 v[64:65], v4 offset:0
  v_mfma_f32_16x16x32_bf16 v[12:15], v[92:95], v[180:183], v[12:15]
  ds_read_b64_tr_b16 v[66:67], v4 offset:3584
  v_mfma_f32_16x16x32_bf16 v[16:19], v[96:99], v[176:179], v[16:19]
  ds_read_b64_tr_b16 v[68:69], v4 offset:32
  buffer_load_dwordx4 v[208:211], v2, s[32:35], s57 offen offset:3072 sc1
  v_mfma_f32_16x16x32_bf16 v[20:23], v[96:99], v[180:183], v[20:23]
  ds_read_b64_tr_b16 v[70:71], v4 offset:3616
  buffer_load_dwordx4 v[212:215], v2, s[32:35], s58 offen offset:3072 sc1
  s_add_u32 s57, s57, 4096
  s_add_u32 s58, s58, 4096
  v_mfma_f32_16x16x32_bf16 v[24:27], v[100:103], v[176:179], v[24:27]
  ds_read_b64_tr_b16 v[72:73], v4 offset:64
  v_mfma_f32_16x16x32_bf16 v[28:31], v[100:103], v[180:183], v[28:31]
  ds_read_b64_tr_b16 v[74:75], v4 offset:3648
  s_waitcnt vmcnt(14)
  s_waitcnt lgkmcnt(10)
  v_mfma_f32_16x16x32_bf16 v[32:35], v[104:107], v[176:179], v[32:35]
  ds_read_b64_tr_b16 v[76:77], v4 offset:96
  v_mfma_f32_16x16x32_bf16 v[36:39], v[104:107], v[180:183], v[36:39]
  ds_read_b64_tr_b16 v[78:79], v4 offset:3680
  ds_read_b64_tr_b16 a[160:161], v249 offset:4096
  ds_read_b64_tr_b16 a[162:163], v249 offset:6144
  v_mfma_f32_16x16x32_bf16 v[40:43], v[108:111], v[176:179], v[40:43]
  ds_read_b64_tr_b16 v[80:81], v4 offset:128
  v_mfma_f32_16x16x32_bf16 v[44:47], v[108:111], v[180:183], v[44:47]
  ds_read_b64_tr_b16 v[82:83], v4 offset:3712
  ds_read_b64_tr_b16 a[164:165], v250 offset:4096
  ds_read_b64_tr_b16 a[166:167], v250 offset:6144
  s_waitcnt lgkmcnt(14)
  v_mfma_f32_16x16x32_bf16 v[48:51], v[112:115], v[176:179], v[48:51]
  ds_read_b64_tr_b16 v[84:85], v4 offset:160
  v_mfma_f32_16x16x32_bf16 v[52:55], v[112:115], v[180:183], v[52:55]
  ds_read_b64_tr_b16 v[86:87], v4 offset:3744
  ds_read_b64_tr_b16 a[168:169], v251 offset:4096
  ds_read_b64_tr_b16 a[170:171], v251 offset:6144
  v_mfma_f32_16x16x32_bf16 v[56:59], v[116:119], v[176:179], v[56:59]
  ds_read_b64_tr_b16 v[88:89], v4 offset:192
  v_mfma_f32_16x16x32_bf16 v[60:63], v[116:119], v[180:183], v[60:63]
  ds_read_b64_tr_b16 v[90:91], v4 offset:3776
  ds_read_b64_tr_b16 a[172:173], v252 offset:4096
  ds_read_b64_tr_b16 a[174:175], v252 offset:6144
  s_waitcnt lgkmcnt(15)
  v_mfma_f32_16x16x32_bf16 v[8:11], v[64:67], v[184:187], v[8:11]
  ds_read_b64_tr_b16 v[92:93], v4 offset:7168
  v_mfma_f32_16x16x32_bf16 v[12:15], v[64:67], v[188:191], v[12:15]
  ds_read_b64_tr_b16 v[94:95], v4 offset:10752
  s_waitcnt lgkmcnt(2)
  s_add_u32 m0, s74, 4096
  s_add_u32 s75, s73, 327680
  buffer_load_dwordx4 v248, s[28:31], s75 offen lds
  v_mfma_f32_16x16x32_bf16 v[16:19], v[68:71], v[184:187], v[16:19]
  ds_read_b64_tr_b16 v[96:97], v4 offset:7200
  buffer_load_dwordx4 v[216:219], v2, s[32:35], s57 offen offset:0 sc1
  v_mfma_f32_16x16x32_bf16 v[20:23], v[68:71], v[188:191], v[20:23]
  ds_read_b64_tr_b16 v[98:99], v4 offset:10784
  buffer_load_dwordx4 v[220:223], v2, s[32:35], s58 offen offset:0 sc1
  v_mfma_f32_16x16x32_bf16 v[24:27], v[72:75], v[184:187], v[24:27]
  ds_read_b64_tr_b16 v[100:101], v4 offset:7232
  v_mfma_f32_16x16x32_bf16 v[28:31], v[72:75], v[188:191], v[28:31]
  ds_read_b64_tr_b16 v[102:103], v4 offset:10816
  s_add_u32 m0, s74, 5120
  s_add_u32 s75, s73, 335872
  buffer_load_dwordx4 v248, s[28:31], s75 offen lds
  s_waitcnt vmcnt(12)
  v_mfma_f32_16x16x32_bf16 v[32:35], v[76:79], v[184:187], v[32:35]
  ds_read_b64_tr_b16 v[104:105], v4 offset:7264
  v_mfma_f32_16x16x32_bf16 v[36:39], v[76:79], v[188:191], v[36:39]
  ds_read_b64_tr_b16 v[106:107], v4 offset:10848
  ds_read_b64_tr_b16 a[176:177], v249 offset:8192
  ds_read_b64_tr_b16 a[178:179], v249 offset:10240
  v_mfma_f32_16x16x32_bf16 v[40:43], v[80:83], v[184:187], v[40:43]
  ds_read_b64_tr_b16 v[108:109], v4 offset:7296
  v_mfma_f32_16x16x32_bf16 v[44:47], v[80:83], v[188:191], v[44:47]
  ds_read_b64_tr_b16 v[110:111], v4 offset:10880
  s_add_u32 m0, s74, 6144
  s_add_u32 s75, s73, 442368
  buffer_load_dwordx4 v248, s[28:31], s75 offen lds
  ds_read_b64_tr_b16 a[180:181], v250 offset:8192
  ds_read_b64_tr_b16 a[182:183], v250 offset:10240
  v_mfma_f32_16x16x32_bf16 v[48:51], v[84:87], v[184:187], v[48:51]
  ds_read_b64_tr_b16 v[112:113], v4 offset:7328
  v_mfma_f32_16x16x32_bf16 v[52:55], v[84:87], v[188:191], v[52:55]
  ds_read_b64_tr_b16 v[114:115], v4 offset:10912
  ds_read_b64_tr_b16 a[184:185], v251 offset:8192
  ds_read_b64_tr_b16 a[186:187], v251 offset:10240
  v_mfma_f32_16x16x32_bf16 v[56:59], v[88:91], v[184:187], v[56:59]
  ds_read_b64_tr_b16 v[116:117], v4 offset:7360
  v_mfma_f32_16x16x32_bf16 v[60:63], v[88:91], v[188:191], v[60:63]
  ds_read_b64_tr_b16 v[118:119], v4 offset:10944
  s_add_u32 m0, s74, 7168
  s_add_u32 s75, s73, 450560
  buffer_load_dwordx4 v248, s[28:31], s75 offen lds
  ds_read_b64_tr_b16 a[188:189], v252 offset:8192
  ds_read_b64_tr_b16 a[190:191], v252 offset:10240
  s_waitcnt lgkmcnt(15)
  v_mfma_f32_16x16x32_bf16 v[8:11], v[92:95], v[192:195], v[8:11]
  ds_read_b64_tr_b16 v[64:65], v4 offset:14336
  v_mfma_f32_16x16x32_bf16 v[12:15], v[92:95], v[196:199], v[12:15]
  ds_read_b64_tr_b16 v[66:67], v4 offset:17920
  v_mfma_f32_16x16x32_bf16 v[16:19], v[96:99], v[192:195], v[16:19]
  ds_read_b64_tr_b16 v[68:69], v4 offset:14368
  buffer_load_dwordx4 v[224:227], v2, s[32:35], s57 offen offset:1024 sc1
  v_mfma_f32_16x16x32_bf16 v[20:23], v[96:99], v[196:199], v[20:23]
  ds_read_b64_tr_b16 v[70:71], v4 offset:17952
  buffer_load_dwordx4 v[228:231], v2, s[32:35], s58 offen offset:1024 sc1
  v_mfma_f32_16x16x32_bf16 v[24:27], v[100:103], v[192:195], v[24:27]
  ds_read_b64_tr_b16 v[72:73], v4 offset:14400
  v_mfma_f32_16x16x32_bf16 v[28:31], v[100:103], v[196:199], v[28:31]
  ds_read_b64_tr_b16 v[74:75], v4 offset:17984
  s_waitcnt vmcnt(10)
  s_waitcnt lgkmcnt(15)
  v_mfma_f32_16x16x32_bf16 v[32:35], v[104:107], v[192:195], v[32:35]
  ds_read_b64_tr_b16 v[76:77], v4 offset:14432
  v_mfma_f32_16x16x32_bf16 v[36:39], v[104:107], v[196:199], v[36:39]
  ds_read_b64_tr_b16 v[78:79], v4 offset:18016
  ds_read_b64_tr_b16 a[192:193], v249 offset:0
  ds_read_b64_tr_b16 a[194:195], v249 offset:2048
  v_mfma_f32_16x16x32_bf16 v[40:43], v[108:111], v[192:195], v[40:43]
  ds_read_b64_tr_b16 v[80:81], v4 offset:14464
  v_mfma_f32_16x16x32_bf16 v[44:47], v[108:111], v[196:199], v[44:47]
  ds_read_b64_tr_b16 v[82:83], v4 offset:18048
  ds_read_b64_tr_b16 a[196:197], v250 offset:0
  ds_read_b64_tr_b16 a[198:199], v250 offset:2048
  s_waitcnt lgkmcnt(15)
  v_mfma_f32_16x16x32_bf16 v[48:51], v[112:115], v[192:195], v[48:51]
  ds_read_b64_tr_b16 v[84:85], v4 offset:14496
  v_mfma_f32_16x16x32_bf16 v[52:55], v[112:115], v[196:199], v[52:55]
  ds_read_b64_tr_b16 v[86:87], v4 offset:18080
  ds_read_b64_tr_b16 a[200:201], v251 offset:0
  ds_read_b64_tr_b16 a[202:203], v251 offset:2048
  v_mfma_f32_16x16x32_bf16 v[56:59], v[116:119], v[192:195], v[56:59]
  ds_read_b64_tr_b16 v[88:89], v4 offset:14528
  v_mfma_f32_16x16x32_bf16 v[60:63], v[116:119], v[196:199], v[60:63]
  ds_read_b64_tr_b16 v[90:91], v4 offset:18112
  ds_read_b64_tr_b16 a[204:205], v252 offset:0
  ds_read_b64_tr_b16 a[206:207], v252 offset:2048
  s_waitcnt lgkmcnt(15)
  v_mfma_f32_16x16x32_bf16 v[8:11], v[64:67], v[200:203], v[8:11]
  ds_read_b64_tr_b16 v[92:93], v4 offset:21504
  v_mfma_f32_16x16x32_bf16 v[12:15], v[64:67], v[204:207], v[12:15]
  ds_read_b64_tr_b16 v[94:95], v4 offset:25088
  v_mfma_f32_16x16x32_bf16 v[16:19], v[68:71], v[200:203], v[16:19]
  ds_read_b64_tr_b16 v[96:97], v4 offset:21536
  buffer_load_dwordx4 v[232:235], v2, s[32:35], s57 offen offset:2048 sc1
  v_mfma_f32_16x16x32_bf16 v[20:23], v[68:71], v[204:207], v[20:23]
  ds_read_b64_tr_b16 v[98:99], v4 offset:25120
  buffer_load_dwordx4 v[236:239], v2, s[32:35], s58 offen offset:2048 sc1
  v_mfma_f32_16x16x32_bf16 v[24:27], v[72:75], v[200:203], v[24:27]
  ds_read_b64_tr_b16 v[100:101], v4 offset:21568
  v_mfma_f32_16x16x32_bf16 v[28:31], v[72:75], v[204:207], v[28:31]
  ds_read_b64_tr_b16 v[102:103], v4 offset:25152
  s_waitcnt lgkmcnt(15)
  v_mfma_f32_16x16x32_bf16 v[32:35], v[76:79], v[200:203], v[32:35]
  ds_read_b64_tr_b16 v[104:105], v4 offset:21600
  v_mfma_f32_16x16x32_bf16 v[36:39], v[76:79], v[204:207], v[36:39]
  ds_read_b64_tr_b16 v[106:107], v4 offset:25184
  v_mfma_f32_16x16x32_bf16 v[40:43], v[80:83], v[200:203], v[40:43]
  ds_read_b64_tr_b16 v[108:109], v4 offset:21632
  v_mfma_f32_16x16x32_bf16 v[44:47], v[80:83], v[204:207], v[44:47]
  ds_read_b64_tr_b16 v[110:111], v4 offset:25216
  s_waitcnt lgkmcnt(12)
  v_mfma_f32_16x16x32_bf16 v[48:51], v[84:87], v[200:203], v[48:51]
  ds_read_b64_tr_b16 v[112:113], v4 offset:21664
  v_mfma_f32_16x16x32_bf16 v[52:55], v[84:87], v[204:207], v[52:55]
  ds_read_b64_tr_b16 v[114:115], v4 offset:25248
  v_mfma_f32_16x16x32_bf16 v[56:59], v[88:91], v[200:203], v[56:59]
  ds_read_b64_tr_b16 v[116:117], v4 offset:21696
  v_mfma_f32_16x16x32_bf16 v[60:63], v[88:91], v[204:207], v[60:63]
  ds_read_b64_tr_b16 v[118:119], v4 offset:25280
  s_waitcnt vmcnt(10) lgkmcnt(8)
  v_mfma_f32_16x16x32_bf16 v[8:11], v[92:95], v[208:211], v[8:11]
  ds_read_b64_tr_b16 v[64:65], v4 offset:28672
  v_mfma_f32_16x16x32_bf16 v[12:15], v[92:95], v[212:215], v[12:15]
  ds_read_b64_tr_b16 v[66:67], v4 offset:32256
  v_mfma_f32_16x16x32_bf16 v[16:19], v[96:99], v[208:211], v[16:19]
  ds_read_b64_tr_b16 v[68:69], v4 offset:28704
  buffer_load_dwordx4 v[240:243], v2, s[32:35], s57 offen offset:3072 sc1
  v_mfma_f32_16x16x32_bf16 v[20:23], v[96:99], v[212:215], v[20:23]
  ds_read_b64_tr_b16 v[70:71], v4 offset:32288
  buffer_load_dwordx4 v[244:247], v2, s[32:35], s58 offen offset:3072 sc1
  s_add_u32 s57, s57, 4096
  s_add_u32 s58, s58, 4096
  v_mfma_f32_16x16x32_bf16 v[24:27], v[100:103], v[208:211], v[24:27]
  ds_read_b64_tr_b16 v[72:73], v4 offset:28736
  v_mfma_f32_16x16x32_bf16 v[28:31], v[100:103], v[212:215], v[28:31]
  ds_read_b64_tr_b16 v[74:75], v4 offset:32320
  s_waitcnt lgkmcnt(10)
  v_mfma_f32_16x16x32_bf16 v[32:35], v[104:107], v[208:211], v[32:35]
  ds_read_b64_tr_b16 v[76:77], v4 offset:28768
  v_mfma_f32_16x16x32_bf16 v[36:39], v[104:107], v[212:215], v[36:39]
  ds_read_b64_tr_b16 v[78:79], v4 offset:32352
  v_mfma_f32_16x16x32_bf16 v[40:43], v[108:111], v[208:211], v[40:43]
  ds_read_b64_tr_b16 v[80:81], v4 offset:28800
  v_mfma_f32_16x16x32_bf16 v[44:47], v[108:111], v[212:215], v[44:47]
  ds_read_b64_tr_b16 v[82:83], v4 offset:32384
  s_waitcnt lgkmcnt(10)
  v_mfma_f32_16x16x32_bf16 v[48:51], v[112:115], v[208:211], v[48:51]
  ds_read_b64_tr_b16 v[84:85], v4 offset:28832
  v_mfma_f32_16x16x32_bf16 v[52:55], v[112:115], v[212:215], v[52:55]
  ds_read_b64_tr_b16 v[86:87], v4 offset:32416
  v_mfma_f32_16x16x32_bf16 v[56:59], v[116:119], v[208:211], v[56:59]
  ds_read_b64_tr_b16 v[88:89], v4 offset:28864
  v_mfma_f32_16x16x32_bf16 v[60:63], v[116:119], v[212:215], v[60:63]
  ds_read_b64_tr_b16 v[90:91], v4 offset:32448
  s_waitcnt vmcnt(9) lgkmcnt(8)
  v_mfma_f32_16x16x32_bf16 v[8:11], v[64:67], v[216:219], v[8:11]
  ds_read_b64_tr_b16 v[92:93], v4 offset:35840
  v_mfma_f32_16x16x32_bf16 v[12:15], v[64:67], v[220:223], v[12:15]
  ds_read_b64_tr_b16 v[94:95], v4 offset:39424
  v_mfma_f32_16x16x32_bf16 v[16:19], v[68:71], v[216:219], v[16:19]
  ds_read_b64_tr_b16 v[96:97], v4 offset:35872
  v_mfma_f32_16x16x32_bf16 v[20:23], v[68:71], v[220:223], v[20:23]
  ds_read_b64_tr_b16 v[98:99], v4 offset:39456
  v_mfma_f32_16x16x32_bf16 v[24:27], v[72:75], v[216:219], v[24:27]
  ds_read_b64_tr_b16 v[100:101], v4 offset:35904
  v_mfma_f32_16x16x32_bf16 v[28:31], v[72:75], v[220:223], v[28:31]
  ds_read_b64_tr_b16 v[102:103], v4 offset:39488
  s_waitcnt lgkmcnt(10)
  v_mfma_f32_16x16x32_bf16 v[32:35], v[76:79], v[216:219], v[32:35]
  ds_read_b64_tr_b16 v[104:105], v4 offset:35936
  v_mfma_f32_16x16x32_bf16 v[36:39], v[76:79], v[220:223], v[36:39]
  ds_read_b64_tr_b16 v[106:107], v4 offset:39520
  v_mfma_f32_16x16x32_bf16 v[40:43], v[80:83], v[216:219], v[40:43]
  ds_read_b64_tr_b16 v[108:109], v4 offset:35968
  v_mfma_f32_16x16x32_bf16 v[44:47], v[80:83], v[220:223], v[44:47]
  ds_read_b64_tr_b16 v[110:111], v4 offset:39552
  s_waitcnt lgkmcnt(10)
  v_mfma_f32_16x16x32_bf16 v[48:51], v[84:87], v[216:219], v[48:51]
  ds_read_b64_tr_b16 v[112:113], v4 offset:36000
  v_mfma_f32_16x16x32_bf16 v[52:55], v[84:87], v[220:223], v[52:55]
  ds_read_b64_tr_b16 v[114:115], v4 offset:39584
  v_mfma_f32_16x16x32_bf16 v[56:59], v[88:91], v[216:219], v[56:59]
  ds_read_b64_tr_b16 v[116:117], v4 offset:36032
  v_mfma_f32_16x16x32_bf16 v[60:63], v[88:91], v[220:223], v[60:63]
  ds_read_b64_tr_b16 v[118:119], v4 offset:39616
  s_waitcnt vmcnt(4) lgkmcnt(8)
  v_mfma_f32_16x16x32_bf16 v[8:11], v[92:95], v[224:227], v[8:11]
  ds_read_b64_tr_b16 v[64:65], v4 offset:43008
  v_mfma_f32_16x16x32_bf16 v[12:15], v[92:95], v[228:231], v[12:15]
  ds_read_b64_tr_b16 v[66:67], v4 offset:46592
  v_mfma_f32_16x16x32_bf16 v[16:19], v[96:99], v[224:227], v[16:19]
  ds_read_b64_tr_b16 v[68:69], v4 offset:43040
  v_mfma_f32_16x16x32_bf16 v[20:23], v[96:99], v[228:231], v[20:23]
  ds_read_b64_tr_b16 v[70:71], v4 offset:46624
  v_mfma_f32_16x16x32_bf16 v[24:27], v[100:103], v[224:227], v[24:27]
  ds_read_b64_tr_b16 v[72:73], v4 offset:43072
  v_mfma_f32_16x16x32_bf16 v[28:31], v[100:103], v[228:231], v[28:31]
  ds_read_b64_tr_b16 v[74:75], v4 offset:46656
  s_waitcnt lgkmcnt(10)
  v_mfma_f32_16x16x32_bf16 v[32:35], v[104:107], v[224:227], v[32:35]
  ds_read_b64_tr_b16 v[76:77], v4 offset:43104
  v_mfma_f32_16x16x32_bf16 v[36:39], v[104:107], v[228:231], v[36:39]
  ds_read_b64_tr_b16 v[78:79], v4 offset:46688
  v_mfma_f32_16x16x32_bf16 v[40:43], v[108:111], v[224:227], v[40:43]
  ds_read_b64_tr_b16 v[80:81], v4 offset:43136
  v_mfma_f32_16x16x32_bf16 v[44:47], v[108:111], v[228:231], v[44:47]
  ds_read_b64_tr_b16 v[82:83], v4 offset:46720
  s_waitcnt lgkmcnt(10)
  v_mfma_f32_16x16x32_bf16 v[48:51], v[112:115], v[224:227], v[48:51]
  ds_read_b64_tr_b16 v[84:85], v4 offset:43168
  v_mfma_f32_16x16x32_bf16 v[52:55], v[112:115], v[228:231], v[52:55]
  ds_read_b64_tr_b16 v[86:87], v4 offset:46752
  v_mfma_f32_16x16x32_bf16 v[56:59], v[116:119], v[224:227], v[56:59]
  ds_read_b64_tr_b16 v[88:89], v4 offset:43200
  v_mfma_f32_16x16x32_bf16 v[60:63], v[116:119], v[228:231], v[60:63]
  ds_read_b64_tr_b16 v[90:91], v4 offset:46784
  s_waitcnt vmcnt(2) lgkmcnt(8)
  v_mfma_f32_16x16x32_bf16 v[8:11], v[64:67], v[232:235], v[8:11]
  ds_read_b64_tr_b16 v[92:93], v4 offset:50176
  v_mfma_f32_16x16x32_bf16 v[12:15], v[64:67], v[236:239], v[12:15]
  ds_read_b64_tr_b16 v[94:95], v4 offset:53760
  v_mfma_f32_16x16x32_bf16 v[16:19], v[68:71], v[232:235], v[16:19]
  ds_read_b64_tr_b16 v[96:97], v4 offset:50208
  v_mfma_f32_16x16x32_bf16 v[20:23], v[68:71], v[236:239], v[20:23]
  ds_read_b64_tr_b16 v[98:99], v4 offset:53792
  v_mfma_f32_16x16x32_bf16 v[24:27], v[72:75], v[232:235], v[24:27]
  ds_read_b64_tr_b16 v[100:101], v4 offset:50240
  v_mfma_f32_16x16x32_bf16 v[28:31], v[72:75], v[236:239], v[28:31]
  ds_read_b64_tr_b16 v[102:103], v4 offset:53824
  s_waitcnt lgkmcnt(10)
  v_mfma_f32_16x16x32_bf16 v[32:35], v[76:79], v[232:235], v[32:35]
  ds_read_b64_tr_b16 v[104:105], v4 offset:50272
  v_mfma_f32_16x16x32_bf16 v[36:39], v[76:79], v[236:239], v[36:39]
  ds_read_b64_tr_b16 v[106:107], v4 offset:53856
  v_mfma_f32_16x16x32_bf16 v[40:43], v[80:83], v[232:235], v[40:43]
  ds_read_b64_tr_b16 v[108:109], v4 offset:50304
  v_mfma_f32_16x16x32_bf16 v[44:47], v[80:83], v[236:239], v[44:47]
  ds_read_b64_tr_b16 v[110:111], v4 offset:53888
  s_waitcnt lgkmcnt(10)
  v_mfma_f32_16x16x32_bf16 v[48:51], v[84:87], v[232:235], v[48:51]
  ds_read_b64_tr_b16 v[112:113], v4 offset:50336
  v_mfma_f32_16x16x32_bf16 v[52:55], v[84:87], v[236:239], v[52:55]
  ds_read_b64_tr_b16 v[114:115], v4 offset:53920
  v_mfma_f32_16x16x32_bf16 v[56:59], v[88:91], v[232:235], v[56:59]
  ds_read_b64_tr_b16 v[116:117], v4 offset:50368
  v_mfma_f32_16x16x32_bf16 v[60:63], v[88:91], v[236:239], v[60:63]
  ds_read_b64_tr_b16 v[118:119], v4 offset:53952
  s_waitcnt vmcnt(0) lgkmcnt(8)
  v_mfma_f32_16x16x32_bf16 v[8:11], v[92:95], v[240:243], v[8:11]
  v_mfma_f32_16x16x32_bf16 v[12:15], v[92:95], v[244:247], v[12:15]
  v_mfma_f32_16x16x32_bf16 v[16:19], v[96:99], v[240:243], v[16:19]
  v_mfma_f32_16x16x32_bf16 v[20:23], v[96:99], v[244:247], v[20:23]
  v_mfma_f32_16x16x32_bf16 v[24:27], v[100:103], v[240:243], v[24:27]
  v_mfma_f32_16x16x32_bf16 v[28:31], v[100:103], v[244:247], v[28:31]
  s_waitcnt lgkmcnt(4)
  v_mfma_f32_16x16x32_bf16 v[32:35], v[104:107], v[240:243], v[32:35]
  v_mfma_f32_16x16x32_bf16 v[36:39], v[104:107], v[244:247], v[36:39]
  v_mfma_f32_16x16x32_bf16 v[40:43], v[108:111], v[240:243], v[40:43]
  v_mfma_f32_16x16x32_bf16 v[44:47], v[108:111], v[244:247], v[44:47]
  s_waitcnt lgkmcnt(0)
  v_mfma_f32_16x16x32_bf16 v[48:51], v[112:115], v[240:243], v[48:51]
  v_mfma_f32_16x16x32_bf16 v[52:55], v[112:115], v[244:247], v[52:55]
  v_mfma_f32_16x16x32_bf16 v[56:59], v[116:119], v[240:243], v[56:59]
  v_mfma_f32_16x16x32_bf16 v[60:63], v[116:119], v[244:247], v[60:63]
  v_mov_b32 v64, 0xbdd2d3e8
  v_mov_b32 v66, 0xc0135761
  v_mov_b32 v68, 1.0
  s_lshl_b32 s57, s4, 4
  s_lshl_b32 s58, s93, 3
  s_add_u32 s57, s57, s58
  s_lshl_b32 s58, s6, 1
  s_add_u32 s57, s57, s58
  s_mul_i32 s57, s57, 57344
  s_add_u32 s57, s57, s72
  s_lshr_b32 s58, s94, 1
  s_mul_i32 s58, s58, 7168
  s_add_u32 s57, s57, s58
  s_and_b32 s59, s94, 1
  s_mul_i32 s58, s59, 3072
  s_add_u32 s58, s57, s58
  s_lshl_b32 s59, s59, 3
  s_add_u32 s59, s57, s59
  s_add_u32 s59, s59, 6144
  s_add_u32 s60, s58, 57344
  s_add_u32 s61, s59, 57344
  v_pk_mul_f32 v[72:73], v[8:9], v[8:9]
  v_pk_mul_f32 v[74:75], v[10:11], v[10:11]
  v_pk_fma_f32 v[72:73], v[72:73], v[64:65], v[66:67] op_sel_hi:[1,0,0]
  v_pk_fma_f32 v[74:75], v[74:75], v[64:65], v[66:67] op_sel_hi:[1,0,0]
  v_pk_mul_f32 v[72:73], v[72:73], v[8:9]
  v_pk_mul_f32 v[74:75], v[74:75], v[10:11]
  v_exp_f32 v72, v72
  v_exp_f32 v73, v73
  v_exp_f32 v74, v74
  v_exp_f32 v75, v75
  v_pk_add_f32 v[72:73], v[72:73], v[68:69] op_sel_hi:[1,0]
  v_pk_add_f32 v[74:75], v[74:75], v[68:69] op_sel_hi:[1,0]
  v_rcp_f32 v72, v72
  v_rcp_f32 v73, v73
  v_rcp_f32 v74, v74
  v_rcp_f32 v75, v75
  v_pk_mul_f32 v[8:9], v[8:9], v[72:73]
  v_pk_mul_f32 v[10:11], v[10:11], v[74:75]
  v_cvt_pk_bf16_f32 v80, v8, v9
  v_cvt_pk_bf16_f32 v81, v10, v11
  v_pk_mul_f32 v[76:77], v[16:17], v[16:17]
  v_pk_mul_f32 v[78:79], v[18:19], v[18:19]
  v_pk_fma_f32 v[76:77], v[76:77], v[64:65], v[66:67] op_sel_hi:[1,0,0]
  v_pk_fma_f32 v[78:79], v[78:79], v[64:65], v[66:67] op_sel_hi:[1,0,0]
  v_pk_mul_f32 v[76:77], v[76:77], v[16:17]
  v_pk_mul_f32 v[78:79], v[78:79], v[18:19]
  v_exp_f32 v76, v76
  v_exp_f32 v77, v77
  v_exp_f32 v78, v78
  v_exp_f32 v79, v79
  v_pk_add_f32 v[76:77], v[76:77], v[68:69] op_sel_hi:[1,0]
  v_pk_add_f32 v[78:79], v[78:79], v[68:69] op_sel_hi:[1,0]
  v_rcp_f32 v76, v76
  v_rcp_f32 v77, v77
  v_rcp_f32 v78, v78
  v_rcp_f32 v79, v79
  v_pk_mul_f32 v[16:17], v[16:17], v[76:77]
  v_pk_mul_f32 v[18:19], v[18:19], v[78:79]
  v_cvt_pk_bf16_f32 v82, v16, v17
  v_cvt_pk_bf16_f32 v83, v18, v19
  buffer_store_dwordx4 v[80:83], v2, s[32:35], s58 offen offset:0
  ds_read_b64_tr_b16 a[208:209], v249 offset:4096
  ds_read_b64_tr_b16 a[210:211], v249 offset:6144
  ds_read_b64_tr_b16 a[212:213], v250 offset:4096
  ds_read_b64_tr_b16 a[214:215], v250 offset:6144
  ds_read_b64_tr_b16 a[216:217], v251 offset:4096
  ds_read_b64_tr_b16 a[218:219], v251 offset:6144
  ds_read_b64_tr_b16 a[220:221], v252 offset:4096
  ds_read_b64_tr_b16 a[222:223], v252 offset:6144
  v_pk_mul_f32 v[72:73], v[24:25], v[24:25]
  v_pk_mul_f32 v[74:75], v[26:27], v[26:27]
  v_pk_fma_f32 v[72:73], v[72:73], v[64:65], v[66:67] op_sel_hi:[1,0,0]
  v_pk_fma_f32 v[74:75], v[74:75], v[64:65], v[66:67] op_sel_hi:[1,0,0]
  v_pk_mul_f32 v[72:73], v[72:73], v[24:25]
  v_pk_mul_f32 v[74:75], v[74:75], v[26:27]
  v_exp_f32 v72, v72
  v_exp_f32 v73, v73
  v_exp_f32 v74, v74
  v_exp_f32 v75, v75
  v_pk_add_f32 v[72:73], v[72:73], v[68:69] op_sel_hi:[1,0]
  v_pk_add_f32 v[74:75], v[74:75], v[68:69] op_sel_hi:[1,0]
  v_rcp_f32 v72, v72
  v_rcp_f32 v73, v73
  v_rcp_f32 v74, v74
  v_rcp_f32 v75, v75
  v_pk_mul_f32 v[24:25], v[24:25], v[72:73]
  v_pk_mul_f32 v[26:27], v[26:27], v[74:75]
  v_cvt_pk_bf16_f32 v84, v24, v25
  v_cvt_pk_bf16_f32 v85, v26, v27
  v_pk_mul_f32 v[76:77], v[32:33], v[32:33]
  v_pk_mul_f32 v[78:79], v[34:35], v[34:35]
  v_pk_fma_f32 v[76:77], v[76:77], v[64:65], v[66:67] op_sel_hi:[1,0,0]
  v_pk_fma_f32 v[78:79], v[78:79], v[64:65], v[66:67] op_sel_hi:[1,0,0]
  v_pk_mul_f32 v[76:77], v[76:77], v[32:33]
  v_pk_mul_f32 v[78:79], v[78:79], v[34:35]
  v_exp_f32 v76, v76
  v_exp_f32 v77, v77
  v_exp_f32 v78, v78
  v_exp_f32 v79, v79
  v_pk_add_f32 v[76:77], v[76:77], v[68:69] op_sel_hi:[1,0]
  v_pk_add_f32 v[78:79], v[78:79], v[68:69] op_sel_hi:[1,0]
  v_rcp_f32 v76, v76
  v_rcp_f32 v77, v77
  v_rcp_f32 v78, v78
  v_rcp_f32 v79, v79
  v_pk_mul_f32 v[32:33], v[32:33], v[76:77]
  v_pk_mul_f32 v[34:35], v[34:35], v[78:79]
  v_cvt_pk_bf16_f32 v86, v32, v33
  v_cvt_pk_bf16_f32 v87, v34, v35
  buffer_store_dwordx4 v[84:87], v2, s[32:35], s58 offen offset:1024
  v_pk_mul_f32 v[72:73], v[40:41], v[40:41]
  v_pk_mul_f32 v[74:75], v[42:43], v[42:43]
  v_pk_fma_f32 v[72:73], v[72:73], v[64:65], v[66:67] op_sel_hi:[1,0,0]
  v_pk_fma_f32 v[74:75], v[74:75], v[64:65], v[66:67] op_sel_hi:[1,0,0]
  v_pk_mul_f32 v[72:73], v[72:73], v[40:41]
  v_pk_mul_f32 v[74:75], v[74:75], v[42:43]
  v_exp_f32 v72, v72
  v_exp_f32 v73, v73
  v_exp_f32 v74, v74
  v_exp_f32 v75, v75
  v_pk_add_f32 v[72:73], v[72:73], v[68:69] op_sel_hi:[1,0]
  v_pk_add_f32 v[74:75], v[74:75], v[68:69] op_sel_hi:[1,0]
  v_rcp_f32 v72, v72
  v_rcp_f32 v73, v73
  v_rcp_f32 v74, v74
  v_rcp_f32 v75, v75
  v_pk_mul_f32 v[40:41], v[40:41], v[72:73]
  v_pk_mul_f32 v[42:43], v[42:43], v[74:75]
  v_cvt_pk_bf16_f32 v88, v40, v41
  v_cvt_pk_bf16_f32 v89, v42, v43
  v_pk_mul_f32 v[76:77], v[48:49], v[48:49]
  v_pk_mul_f32 v[78:79], v[50:51], v[50:51]
  v_pk_fma_f32 v[76:77], v[76:77], v[64:65], v[66:67] op_sel_hi:[1,0,0]
  v_pk_fma_f32 v[78:79], v[78:79], v[64:65], v[66:67] op_sel_hi:[1,0,0]
  v_pk_mul_f32 v[76:77], v[76:77], v[48:49]
  v_pk_mul_f32 v[78:79], v[78:79], v[50:51]
  v_exp_f32 v76, v76
  v_exp_f32 v77, v77
  v_exp_f32 v78, v78
  v_exp_f32 v79, v79
  v_pk_add_f32 v[76:77], v[76:77], v[68:69] op_sel_hi:[1,0]
  v_pk_add_f32 v[78:79], v[78:79], v[68:69] op_sel_hi:[1,0]
  v_rcp_f32 v76, v76
  v_rcp_f32 v77, v77
  v_rcp_f32 v78, v78
  v_rcp_f32 v79, v79
  v_pk_mul_f32 v[48:49], v[48:49], v[76:77]
  v_pk_mul_f32 v[50:51], v[50:51], v[78:79]
  v_cvt_pk_bf16_f32 v90, v48, v49
  v_cvt_pk_bf16_f32 v91, v50, v51
  buffer_store_dwordx4 v[88:91], v2, s[32:35], s58 offen offset:2048
  v_pk_mul_f32 v[72:73], v[56:57], v[56:57]
  v_pk_mul_f32 v[74:75], v[58:59], v[58:59]
  v_pk_fma_f32 v[72:73], v[72:73], v[64:65], v[66:67] op_sel_hi:[1,0,0]
  v_pk_fma_f32 v[74:75], v[74:75], v[64:65], v[66:67] op_sel_hi:[1,0,0]
  v_pk_mul_f32 v[72:73], v[72:73], v[56:57]
  v_pk_mul_f32 v[74:75], v[74:75], v[58:59]
  v_exp_f32 v72, v72
  v_exp_f32 v73, v73
  v_exp_f32 v74, v74
  v_exp_f32 v75, v75
  v_pk_add_f32 v[72:73], v[72:73], v[68:69] op_sel_hi:[1,0]
  v_pk_add_f32 v[74:75], v[74:75], v[68:69] op_sel_hi:[1,0]
  v_rcp_f32 v72, v72
  v_rcp_f32 v73, v73
  v_rcp_f32 v74, v74
  v_rcp_f32 v75, v75
  v_pk_mul_f32 v[56:57], v[56:57], v[72:73]
  v_pk_mul_f32 v[58:59], v[58:59], v[74:75]
  v_cvt_pk_bf16_f32 v92, v56, v57
  v_cvt_pk_bf16_f32 v93, v58, v59
  buffer_store_dwordx2 v[92:93], v2, s[32:35], s59 offen
  v_pk_mul_f32 v[76:77], v[12:13], v[12:13]
  v_pk_mul_f32 v[78:79], v[14:15], v[14:15]
  v_pk_fma_f32 v[76:77], v[76:77], v[64:65], v[66:67] op_sel_hi:[1,0,0]
  v_pk_fma_f32 v[78:79], v[78:79], v[64:65], v[66:67] op_sel_hi:[1,0,0]
  v_pk_mul_f32 v[76:77], v[76:77], v[12:13]
  v_pk_mul_f32 v[78:79], v[78:79], v[14:15]
  v_exp_f32 v76, v76
  v_exp_f32 v77, v77
  v_exp_f32 v78, v78
  v_exp_f32 v79, v79
  v_pk_add_f32 v[76:77], v[76:77], v[68:69] op_sel_hi:[1,0]
  v_pk_add_f32 v[78:79], v[78:79], v[68:69] op_sel_hi:[1,0]
  v_rcp_f32 v76, v76
  v_rcp_f32 v77, v77
  v_rcp_f32 v78, v78
  v_rcp_f32 v79, v79
  v_pk_mul_f32 v[12:13], v[12:13], v[76:77]
  v_pk_mul_f32 v[14:15], v[14:15], v[78:79]
  v_cvt_pk_bf16_f32 v96, v12, v13
  v_cvt_pk_bf16_f32 v97, v14, v15
  v_pk_mul_f32 v[72:73], v[20:21], v[20:21]
  v_pk_mul_f32 v[74:75], v[22:23], v[22:23]
  v_pk_fma_f32 v[72:73], v[72:73], v[64:65], v[66:67] op_sel_hi:[1,0,0]
  v_pk_fma_f32 v[74:75], v[74:75], v[64:65], v[66:67] op_sel_hi:[1,0,0]
  v_pk_mul_f32 v[72:73], v[72:73], v[20:21]
  v_pk_mul_f32 v[74:75], v[74:75], v[22:23]
  v_exp_f32 v72, v72
  v_exp_f32 v73, v73
  v_exp_f32 v74, v74
  v_exp_f32 v75, v75
  v_pk_add_f32 v[72:73], v[72:73], v[68:69] op_sel_hi:[1,0]
  v_pk_add_f32 v[74:75], v[74:75], v[68:69] op_sel_hi:[1,0]
  v_rcp_f32 v72, v72
  v_rcp_f32 v73, v73
  v_rcp_f32 v74, v74
  v_rcp_f32 v75, v75
  v_pk_mul_f32 v[20:21], v[20:21], v[72:73]
  v_pk_mul_f32 v[22:23], v[22:23], v[74:75]
  v_cvt_pk_bf16_f32 v98, v20, v21
  v_cvt_pk_bf16_f32 v99, v22, v23
  buffer_store_dwordx4 v[96:99], v2, s[32:35], s60 offen offset:0
  v_pk_mul_f32 v[76:77], v[28:29], v[28:29]
  v_pk_mul_f32 v[78:79], v[30:31], v[30:31]
  v_pk_fma_f32 v[76:77], v[76:77], v[64:65], v[66:67] op_sel_hi:[1,0,0]
  v_pk_fma_f32 v[78:79], v[78:79], v[64:65], v[66:67] op_sel_hi:[1,0,0]
  v_pk_mul_f32 v[76:77], v[76:77], v[28:29]
  v_pk_mul_f32 v[78:79], v[78:79], v[30:31]
  v_exp_f32 v76, v76
  v_exp_f32 v77, v77
  v_exp_f32 v78, v78
  v_exp_f32 v79, v79
  v_pk_add_f32 v[76:77], v[76:77], v[68:69] op_sel_hi:[1,0]
  v_pk_add_f32 v[78:79], v[78:79], v[68:69] op_sel_hi:[1,0]
  v_rcp_f32 v76, v76
  v_rcp_f32 v77, v77
  v_rcp_f32 v78, v78
  v_rcp_f32 v79, v79
  v_pk_mul_f32 v[28:29], v[28:29], v[76:77]
  v_pk_mul_f32 v[30:31], v[30:31], v[78:79]
  v_cvt_pk_bf16_f32 v100, v28, v29
  v_cvt_pk_bf16_f32 v101, v30, v31
  v_pk_mul_f32 v[72:73], v[36:37], v[36:37]
  v_pk_mul_f32 v[74:75], v[38:39], v[38:39]
  v_pk_fma_f32 v[72:73], v[72:73], v[64:65], v[66:67] op_sel_hi:[1,0,0]
  v_pk_fma_f32 v[74:75], v[74:75], v[64:65], v[66:67] op_sel_hi:[1,0,0]
  v_pk_mul_f32 v[72:73], v[72:73], v[36:37]
  v_pk_mul_f32 v[74:75], v[74:75], v[38:39]
  v_exp_f32 v72, v72
  v_exp_f32 v73, v73
  v_exp_f32 v74, v74
  v_exp_f32 v75, v75
  v_pk_add_f32 v[72:73], v[72:73], v[68:69] op_sel_hi:[1,0]
  v_pk_add_f32 v[74:75], v[74:75], v[68:69] op_sel_hi:[1,0]
  v_rcp_f32 v72, v72
  v_rcp_f32 v73, v73
  v_rcp_f32 v74, v74
  v_rcp_f32 v75, v75
  v_pk_mul_f32 v[36:37], v[36:37], v[72:73]
  v_pk_mul_f32 v[38:39], v[38:39], v[74:75]
  v_cvt_pk_bf16_f32 v102, v36, v37
  v_cvt_pk_bf16_f32 v103, v38, v39
  buffer_store_dwordx4 v[100:103], v2, s[32:35], s60 offen offset:1024
  v_pk_mul_f32 v[76:77], v[44:45], v[44:45]
  v_pk_mul_f32 v[78:79], v[46:47], v[46:47]
  v_pk_fma_f32 v[76:77], v[76:77], v[64:65], v[66:67] op_sel_hi:[1,0,0]
  v_pk_fma_f32 v[78:79], v[78:79], v[64:65], v[66:67] op_sel_hi:[1,0,0]
  v_pk_mul_f32 v[76:77], v[76:77], v[44:45]
  v_pk_mul_f32 v[78:79], v[78:79], v[46:47]
  v_exp_f32 v76, v76
  v_exp_f32 v77, v77
  v_exp_f32 v78, v78
  v_exp_f32 v79, v79
  v_pk_add_f32 v[76:77], v[76:77], v[68:69] op_sel_hi:[1,0]
  v_pk_add_f32 v[78:79], v[78:79], v[68:69] op_sel_hi:[1,0]
  v_rcp_f32 v76, v76
  v_rcp_f32 v77, v77
  v_rcp_f32 v78, v78
  v_rcp_f32 v79, v79
  v_pk_mul_f32 v[44:45], v[44:45], v[76:77]
  v_pk_mul_f32 v[46:47], v[46:47], v[78:79]
  v_cvt_pk_bf16_f32 v104, v44, v45
  v_cvt_pk_bf16_f32 v105, v46, v47
  v_pk_mul_f32 v[72:73], v[52:53], v[52:53]
  v_pk_mul_f32 v[74:75], v[54:55], v[54:55]
  v_pk_fma_f32 v[72:73], v[72:73], v[64:65], v[66:67] op_sel_hi:[1,0,0]
  v_pk_fma_f32 v[74:75], v[74:75], v[64:65], v[66:67] op_sel_hi:[1,0,0]
  v_pk_mul_f32 v[72:73], v[72:73], v[52:53]
  v_pk_mul_f32 v[74:75], v[74:75], v[54:55]
  v_exp_f32 v72, v72
  v_exp_f32 v73, v73
  v_exp_f32 v74, v74
  v_exp_f32 v75, v75
  v_pk_add_f32 v[72:73], v[72:73], v[68:69] op_sel_hi:[1,0]
  v_pk_add_f32 v[74:75], v[74:75], v[68:69] op_sel_hi:[1,0]
  v_rcp_f32 v72, v72
  v_rcp_f32 v73, v73
  v_rcp_f32 v74, v74
  v_rcp_f32 v75, v75
  v_pk_mul_f32 v[52:53], v[52:53], v[72:73]
  v_pk_mul_f32 v[54:55], v[54:55], v[74:75]
  v_cvt_pk_bf16_f32 v106, v52, v53
  v_cvt_pk_bf16_f32 v107, v54, v55
  buffer_store_dwordx4 v[104:107], v2, s[32:35], s60 offen offset:2048
  v_pk_mul_f32 v[76:77], v[60:61], v[60:61]
  v_pk_mul_f32 v[78:79], v[62:63], v[62:63]
  v_pk_fma_f32 v[76:77], v[76:77], v[64:65], v[66:67] op_sel_hi:[1,0,0]
  v_pk_fma_f32 v[78:79], v[78:79], v[64:65], v[66:67] op_sel_hi:[1,0,0]
  v_pk_mul_f32 v[76:77], v[76:77], v[60:61]
  v_pk_mul_f32 v[78:79], v[78:79], v[62:63]
  v_exp_f32 v76, v76
  v_exp_f32 v77, v77
  v_exp_f32 v78, v78
  v_exp_f32 v79, v79
  v_pk_add_f32 v[76:77], v[76:77], v[68:69] op_sel_hi:[1,0]
  v_pk_add_f32 v[78:79], v[78:79], v[68:69] op_sel_hi:[1,0]
  v_rcp_f32 v76, v76
  v_rcp_f32 v77, v77
  v_rcp_f32 v78, v78
  v_rcp_f32 v79, v79
  v_pk_mul_f32 v[60:61], v[60:61], v[76:77]
  v_pk_mul_f32 v[62:63], v[62:63], v[78:79]
  v_cvt_pk_bf16_f32 v108, v60, v61
  v_cvt_pk_bf16_f32 v109, v62, v63
  buffer_store_dwordx2 v[108:109], v2, s[32:35], s61 offen
  s_waitcnt vmcnt(0) lgkmcnt(0)
  s_cmp_eq_u32 s100, 1
  s_cbranch_scc1 L_sigp_36
  buffer_wbl2 sc1
  s_waitcnt vmcnt(0)
L_sigp_36:
  s_barrier
  s_cmp_lg_u32 s6, 0
  s_cbranch_scc1 L_sig_35
  s_lshl_b32 s57, s52, 2
  s_add_u32 s57, s57, 6144
  v_mov_b32 v2, s98
  s_mov_b64 exec, 1
  s_cmp_eq_u32 s100, 1
  s_cbranch_scc1 L_stp_37
  buffer_store_dword v2, off, s[32:35], s57 sc1
  s_branch L_std_38
L_stp_37:
  buffer_store_dword v2, off, s[32:35], s57
L_std_38:
  s_mov_b64 exec, -1
L_sig_35:
  v_lshrrev_b32 v5, 4, v1
  v_lshlrev_b32 v5, 3, v5
  s_lshl_b32 s59, s96, 7
  buffer_load_dwordx2 v[216:217], v5, s[48:51], s59 offen offset:0
  buffer_load_dwordx2 v[218:219], v5, s[48:51], s59 offen offset:32
  buffer_load_dwordx2 v[220:221], v5, s[48:51], s59 offen offset:64
  buffer_load_dwordx2 v[222:223], v5, s[48:51], s59 offen offset:96
  v_mov_b32 v226, s98
  v_mov_b32 v227, s99
  v_mov_b32 v230, s98
  v_mov_b32 v231, s99
  v_mov_b32 v234, s98
  v_mov_b32 v235, s99
  v_mov_b32 v238, s98
  v_mov_b32 v239, s99
  s_lshl_b32 s62, s4, 5
  s_lshl_b32 s61, s93, 4
  s_add_u32 s62, s62, s61
  s_lshl_b32 s57, s62, 2
  s_add_u32 s57, s57, 6144
  v_min_u32 v2, 15, v1
  v_lshlrev_b32 v2, 2, v2
  s_mov_b32 s56, 262144
L_poll_39:
  buffer_load_dword v3, v2, s[32:35], s57 offen sc1
  s_waitcnt vmcnt(0)
  v_cmp_ne_u32 vcc, s98, v3
  s_cbranch_vccz L_polld_40
  s_sub_u32 s56, s56, 1
  s_cbranch_scc1 L_polt_41
  s_sleep 1
  s_branch L_poll_39
L_polt_41:
L_polld_40:
  s_cmp_eq_u32 s100, 1
  s_cbranch_scc1 L_acq_42
  buffer_inv sc1
  s_waitcnt vmcnt(0)
L_acq_42:
  v_lshlrev_b32 v2, 4, v1
  s_lshl_b32 s57, s4, 4
  s_lshl_b32 s58, s95, 2
  s_add_u32 s57, s57, s58
  s_mul_i32 s57, s57, 57344
  s_mul_i32 s58, s86, 14336
  s_add_u32 s57, s57, s58
  s_add_u32 s57, s57, s72
  s_add_u32 s58, s6, 1
  s_and_b32 s58, s58, 3
  s_mul_i32 s58, s58, 57344
  s_add_u32 s76, s58, s57
  s_add_u32 s58, s6, 2
  s_and_b32 s58, s58, 3
  s_mul_i32 s58, s58, 57344
  s_add_u32 s77, s58, s57
  s_add_u32 s58, s6, 3
  s_and_b32 s58, s58, 3
  s_mul_i32 s58, s58, 57344
  s_add_u32 s78, s58, s57
  s_add_u32 s58, s6, 4
  s_and_b32 s58, s58, 3
  s_mul_i32 s58, s58, 57344
  s_add_u32 s79, s58, s57
  buffer_load_dwordx4 v[40:43], v2, s[32:35], s76 offen offset:0 sc1
  buffer_load_dwordx4 v[44:47], v2, s[32:35], s76 offen offset:1024 sc1
  buffer_load_dwordx4 v[48:51], v2, s[32:35], s76 offen offset:2048 sc1
  buffer_load_dwordx4 v[52:55], v2, s[32:35], s76 offen offset:3072 sc1
  s_add_u32 s76, s76, 4096
  buffer_load_dwordx4 v[56:59], v2, s[32:35], s76 offen offset:0 sc1
  buffer_load_dwordx4 v[60:63], v2, s[32:35], s76 offen offset:1024 sc1
  buffer_load_dwordx4 v[64:67], v2, s[32:35], s76 offen offset:2048 sc1
  buffer_load_dwordx4 v[68:71], v2, s[32:35], s76 offen offset:3072 sc1
  s_add_u32 s76, s76, 4096
  buffer_load_dwordx4 v[72:75], v2, s[32:35], s76 offen offset:0 sc1
  buffer_load_dwordx4 v[76:79], v2, s[32:35], s76 offen offset:1024 sc1
  buffer_load_dwordx4 v[80:83], v2, s[32:35], s76 offen offset:2048 sc1
  buffer_load_dwordx4 v[84:87], v2, s[32:35], s76 offen offset:3072 sc1
  s_add_u32 s76, s76, 4096
  buffer_load_dwordx4 v[88:91], v2, s[32:35], s76 offen offset:0 sc1
  buffer_load_dwordx4 v[92:95], v2, s[32:35], s76 offen offset:1024 sc1
  v_lshlrev_b32 v3, 4, v1
  s_add_u32 s58, s6, 1
  s_and_b32 s58, s58, 3
  s_mul_i32 s58, s58, 12288
  s_add_u32 s58, s58, 122880
  v_add_u32 v5, s58, v3
  s_add_u32 s58, s6, 2
  s_and_b32 s58, s58, 3
  s_mul_i32 s58, s58, 12288
  s_add_u32 s58, s58, 118784
  v_add_u32 v6, s58, v3
  s_add_u32 s58, s6, 3
  s_and_b32 s58, s58, 3
  s_mul_i32 s58, s58, 12288
  s_add_u32 s58, s58, 114688
  v_add_u32 v7, s58, v3
  s_mul_i32 s58, s6, 12288
  s_add_u32 s58, s58, 114688
  v_add_u32 v4, s58, v3
  s_waitcnt vmcnt(13)
  v_mfma_f32_16x16x32_bf16 v[8:11], a[0:3], v[40:43], 0
  v_mfma_f32_16x16x32_bf16 v[12:15], a[4:7], v[40:43], 0
  buffer_load_dwordx4 v[96:99], v2, s[32:35], s77 offen offset:0 sc1
  v_mfma_f32_16x16x32_bf16 v[16:19], a[8:11], v[40:43], 0
  v_mfma_f32_16x16x32_bf16 v[20:23], a[12:15], v[40:43], 0
  s_waitcnt vmcnt(13)
  v_mfma_f32_16x16x32_bf16 v[8:11], a[16:19], v[44:47], v[8:11]
  v_mfma_f32_16x16x32_bf16 v[12:15], a[20:23], v[44:47], v[12:15]
  buffer_load_dwordx4 v[100:103], v2, s[32:35], s77 offen offset:1024 sc1
  v_mfma_f32_16x16x32_bf16 v[16:19], a[24:27], v[44:47], v[16:19]
  v_mfma_f32_16x16x32_bf16 v[20:23], a[28:31], v[44:47], v[20:23]
  s_waitcnt vmcnt(13)
  v_mfma_f32_16x16x32_bf16 v[8:11], a[32:35], v[48:51], v[8:11]
  v_mfma_f32_16x16x32_bf16 v[12:15], a[36:39], v[48:51], v[12:15]
  buffer_load_dwordx4 v[104:107], v2, s[32:35], s77 offen offset:2048 sc1
  v_mfma_f32_16x16x32_bf16 v[16:19], a[40:43], v[48:51], v[16:19]
  v_mfma_f32_16x16x32_bf16 v[20:23], a[44:47], v[48:51], v[20:23]
  s_waitcnt vmcnt(13)
  v_mfma_f32_16x16x32_bf16 v[8:11], a[48:51], v[52:55], v[8:11]
  v_mfma_f32_16x16x32_bf16 v[12:15], a[52:55], v[52:55], v[12:15]
  buffer_load_dwordx4 v[108:111], v2, s[32:35], s77 offen offset:3072 sc1
  v_mfma_f32_16x16x32_bf16 v[16:19], a[56:59], v[52:55], v[16:19]
  v_mfma_f32_16x16x32_bf16 v[20:23], a[60:63], v[52:55], v[20:23]
  s_waitcnt vmcnt(13)
  v_mfma_f32_16x16x32_bf16 v[8:11], a[64:67], v[56:59], v[8:11]
  v_mfma_f32_16x16x32_bf16 v[12:15], a[68:71], v[56:59], v[12:15]
  s_add_u32 s77, s77, 4096
  buffer_load_dwordx4 v[112:115], v2, s[32:35], s77 offen offset:0 sc1
  v_mfma_f32_16x16x32_bf16 v[16:19], a[72:75], v[56:59], v[16:19]
  v_mfma_f32_16x16x32_bf16 v[20:23], a[76:79], v[56:59], v[20:23]
  s_waitcnt vmcnt(13)
  v_mfma_f32_16x16x32_bf16 v[8:11], a[80:83], v[60:63], v[8:11]
  v_mfma_f32_16x16x32_bf16 v[12:15], a[84:87], v[60:63], v[12:15]
  buffer_load_dwordx4 v[116:119], v2, s[32:35], s77 offen offset:1024 sc1
  v_mfma_f32_16x16x32_bf16 v[16:19], a[88:91], v[60:63], v[16:19]
  v_mfma_f32_16x16x32_bf16 v[20:23], a[92:95], v[60:63], v[20:23]
  s_waitcnt vmcnt(13)
  v_mfma_f32_16x16x32_bf16 v[8:11], a[96:99], v[64:67], v[8:11]
  v_mfma_f32_16x16x32_bf16 v[12:15], a[100:103], v[64:67], v[12:15]
  buffer_load_dwordx4 v[120:123], v2, s[32:35], s77 offen offset:2048 sc1
  v_mfma_f32_16x16x32_bf16 v[16:19], a[104:107], v[64:67], v[16:19]
  v_mfma_f32_16x16x32_bf16 v[20:23], a[108:111], v[64:67], v[20:23]
  s_waitcnt vmcnt(13)
  v_mfma_f32_16x16x32_bf16 v[8:11], a[112:115], v[68:71], v[8:11]
  v_mfma_f32_16x16x32_bf16 v[12:15], a[116:119], v[68:71], v[12:15]
  buffer_load_dwordx4 v[124:127], v2, s[32:35], s77 offen offset:3072 sc1
  v_mfma_f32_16x16x32_bf16 v[16:19], a[120:123], v[68:71], v[16:19]
  v_mfma_f32_16x16x32_bf16 v[20:23], a[124:127], v[68:71], v[20:23]
  s_waitcnt vmcnt(13)
  v_mfma_f32_16x16x32_bf16 v[8:11], a[128:131], v[72:75], v[8:11]
  v_mfma_f32_16x16x32_bf16 v[12:15], a[132:135], v[72:75], v[12:15]
  s_add_u32 s77, s77, 4096
  buffer_load_dwordx4 v[128:131], v2, s[32:35], s77 offen offset:0 sc1
  v_mfma_f32_16x16x32_bf16 v[16:19], a[136:139], v[72:75], v[16:19]
  v_mfma_f32_16x16x32_bf16 v[20:23], a[140:143], v[72:75], v[20:23]
  s_waitcnt vmcnt(13)
  v_mfma_f32_16x16x32_bf16 v[8:11], a[144:147], v[76:79], v[8:11]
  v_mfma_f32_16x16x32_bf16 v[12:15], a[148:151], v[76:79], v[12:15]
  buffer_load_dwordx4 v[132:135], v2, s[32:35], s77 offen offset:1024 sc1
  v_mfma_f32_16x16x32_bf16 v[16:19], a[152:155], v[76:79], v[16:19]
  v_mfma_f32_16x16x32_bf16 v[20:23], a[156:159], v[76:79], v[20:23]
  s_waitcnt vmcnt(13)
  v_mfma_f32_16x16x32_bf16 v[8:11], a[160:163], v[80:83], v[8:11]
  v_mfma_f32_16x16x32_bf16 v[12:15], a[164:167], v[80:83], v[12:15]
  buffer_load_dwordx4 v[136:139], v2, s[32:35], s77 offen offset:2048 sc1
  v_mfma_f32_16x16x32_bf16 v[16:19], a[168:171], v[80:83], v[16:19]
  v_mfma_f32_16x16x32_bf16 v[20:23], a[172:175], v[80:83], v[20:23]
  s_waitcnt vmcnt(13)
  v_mfma_f32_16x16x32_bf16 v[8:11], a[176:179], v[84:87], v[8:11]
  v_mfma_f32_16x16x32_bf16 v[12:15], a[180:183], v[84:87], v[12:15]
  buffer_load_dwordx4 v[140:143], v2, s[32:35], s77 offen offset:3072 sc1
  v_mfma_f32_16x16x32_bf16 v[16:19], a[184:187], v[84:87], v[16:19]
  v_mfma_f32_16x16x32_bf16 v[20:23], a[188:191], v[84:87], v[20:23]
  s_waitcnt vmcnt(13)
  v_mfma_f32_16x16x32_bf16 v[8:11], a[192:195], v[88:91], v[8:11]
  v_mfma_f32_16x16x32_bf16 v[12:15], a[196:199], v[88:91], v[12:15]
  s_add_u32 s77, s77, 4096
  buffer_load_dwordx4 v[144:147], v2, s[32:35], s77 offen offset:0 sc1
  v_mfma_f32_16x16x32_bf16 v[16:19], a[200:203], v[88:91], v[16:19]
  v_mfma_f32_16x16x32_bf16 v[20:23], a[204:207], v[88:91], v[20:23]
  s_waitcnt vmcnt(13)
  v_mfma_f32_16x16x32_bf16 v[8:11], a[208:211], v[92:95], v[8:11]
  v_mfma_f32_16x16x32_bf16 v[12:15], a[212:215], v[92:95], v[12:15]
  buffer_load_dwordx4 v[148:151], v2, s[32:35], s77 offen offset:1024 sc1
  v_mfma_f32_16x16x32_bf16 v[16:19], a[216:219], v[92:95], v[16:19]
  v_mfma_f32_16x16x32_bf16 v[20:23], a[220:223], v[92:95], v[20:23]
  s_waitcnt vmcnt(13)
  v_mfma_f32_16x16x32_bf16 v[24:27], a[0:3], v[96:99], 0
  v_mfma_f32_16x16x32_bf16 v[28:31], a[4:7], v[96:99], 0
  buffer_load_dwordx4 v[152:155], v2, s[32:35], s78 offen offset:0 sc1
  v_mfma_f32_16x16x32_bf16 v[32:35], a[8:11], v[96:99], 0
  v_mfma_f32_16x16x32_bf16 v[36:39], a[12:15], v[96:99], 0
  s_waitcnt vmcnt(13)
  v_mfma_f32_16x16x32_bf16 v[24:27], a[16:19], v[100:103], v[24:27]
  v_mfma_f32_16x16x32_bf16 v[28:31], a[20:23], v[100:103], v[28:31]
  buffer_load_dwordx4 v[156:159], v2, s[32:35], s78 offen offset:1024 sc1
  v_mfma_f32_16x16x32_bf16 v[32:35], a[24:27], v[100:103], v[32:35]
  v_mfma_f32_16x16x32_bf16 v[36:39], a[28:31], v[100:103], v[36:39]
  ds_write_b128 v5, v[8:11] offset:0
  s_waitcnt vmcnt(13)
  v_mfma_f32_16x16x32_bf16 v[24:27], a[32:35], v[104:107], v[24:27]
  v_mfma_f32_16x16x32_bf16 v[28:31], a[36:39], v[104:107], v[28:31]
  buffer_load_dwordx4 v[160:163], v2, s[32:35], s78 offen offset:2048 sc1
  v_mfma_f32_16x16x32_bf16 v[32:35], a[40:43], v[104:107], v[32:35]
  v_mfma_f32_16x16x32_bf16 v[36:39], a[44:47], v[104:107], v[36:39]
  ds_write_b128 v5, v[12:15] offset:1024
  s_waitcnt vmcnt(13)
  v_mfma_f32_16x16x32_bf16 v[24:27], a[48:51], v[108:111], v[24:27]
  v_mfma_f32_16x16x32_bf16 v[28:31], a[52:55], v[108:111], v[28:31]
  buffer_load_dwordx4 v[164:167], v2, s[32:35], s78 offen offset:3072 sc1
  v_mfma_f32_16x16x32_bf16 v[32:35], a[56:59], v[108:111], v[32:35]
  v_mfma_f32_16x16x32_bf16 v[36:39], a[60:63], v[108:111], v[36:39]
  ds_write_b128 v5, v[16:19] offset:2048
  s_waitcnt vmcnt(13)
  v_mfma_f32_16x16x32_bf16 v[24:27], a[64:67], v[112:115], v[24:27]
  v_mfma_f32_16x16x32_bf16 v[28:31], a[68:71], v[112:115], v[28:31]
  s_add_u32 s78, s78, 4096
  buffer_load_dwordx4 v[168:171], v2, s[32:35], s78 offen offset:0 sc1
  v_mfma_f32_16x16x32_bf16 v[32:35], a[72:75], v[112:115], v[32:35]
  v_mfma_f32_16x16x32_bf16 v[36:39], a[76:79], v[112:115], v[36:39]
  ds_write_b128 v5, v[20:23] offset:3072
  s_waitcnt vmcnt(13)
  v_mfma_f32_16x16x32_bf16 v[24:27], a[80:83], v[116:119], v[24:27]
  v_mfma_f32_16x16x32_bf16 v[28:31], a[84:87], v[116:119], v[28:31]
  buffer_load_dwordx4 v[172:175], v2, s[32:35], s78 offen offset:1024 sc1
  v_mfma_f32_16x16x32_bf16 v[32:35], a[88:91], v[116:119], v[32:35]
  v_mfma_f32_16x16x32_bf16 v[36:39], a[92:95], v[116:119], v[36:39]
  s_waitcnt vmcnt(13)
  v_mfma_f32_16x16x32_bf16 v[24:27], a[96:99], v[120:123], v[24:27]
  v_mfma_f32_16x16x32_bf16 v[28:31], a[100:103], v[120:123], v[28:31]
  buffer_load_dwordx4 v[176:179], v2, s[32:35], s78 offen offset:2048 sc1
  v_mfma_f32_16x16x32_bf16 v[32:35], a[104:107], v[120:123], v[32:35]
  v_mfma_f32_16x16x32_bf16 v[36:39], a[108:111], v[120:123], v[36:39]
  s_waitcnt vmcnt(13)
  v_mfma_f32_16x16x32_bf16 v[24:27], a[112:115], v[124:127], v[24:27]
  v_mfma_f32_16x16x32_bf16 v[28:31], a[116:119], v[124:127], v[28:31]
  buffer_load_dwordx4 v[180:183], v2, s[32:35], s78 offen offset:3072 sc1
  v_mfma_f32_16x16x32_bf16 v[32:35], a[120:123], v[124:127], v[32:35]
  v_mfma_f32_16x16x32_bf16 v[36:39], a[124:127], v[124:127], v[36:39]
  s_waitcnt vmcnt(13)
  v_mfma_f32_16x16x32_bf16 v[24:27], a[128:131], v[128:131], v[24:27]
  v_mfma_f32_16x16x32_bf16 v[28:31], a[132:135], v[128:131], v[28:31]
  s_add_u32 s78, s78, 4096
  buffer_load_dwordx4 v[184:187], v2, s[32:35], s78 offen offset:0 sc1
  v_mfma_f32_16x16x32_bf16 v[32:35], a[136:139], v[128:131], v[32:35]
  v_mfma_f32_16x16x32_bf16 v[36:39], a[140:143], v[128:131], v[36:39]
  s_waitcnt vmcnt(13)
  v_mfma_f32_16x16x32_bf16 v[24:27], a[144:147], v[132:135], v[24:27]
  v_mfma_f32_16x16x32_bf16 v[28:31], a[148:151], v[132:135], v[28:31]
  buffer_load_dwordx4 v[188:191], v2, s[32:35], s78 offen offset:1024 sc1
  v_mfma_f32_16x16x32_bf16 v[32:35], a[152:155], v[132:135], v[32:35]
  v_mfma_f32_16x16x32_bf16 v[36:39], a[156:159], v[132:135], v[36:39]
  s_waitcnt vmcnt(13)
  v_mfma_f32_16x16x32_bf16 v[24:27], a[160:163], v[136:139], v[24:27]
  v_mfma_f32_16x16x32_bf16 v[28:31], a[164:167], v[136:139], v[28:31]
  buffer_load_dwordx4 v[192:195], v2, s[32:35], s78 offen offset:2048 sc1
  v_mfma_f32_16x16x32_bf16 v[32:35], a[168:171], v[136:139], v[32:35]
  v_mfma_f32_16x16x32_bf16 v[36:39], a[172:175], v[136:139], v[36:39]
  s_waitcnt vmcnt(13)
  v_mfma_f32_16x16x32_bf16 v[24:27], a[176:179], v[140:143], v[24:27]
  v_mfma_f32_16x16x32_bf16 v[28:31], a[180:183], v[140:143], v[28:31]
  buffer_load_dwordx4 v[196:199], v2, s[32:35], s78 offen offset:3072 sc1
  v_mfma_f32_16x16x32_bf16 v[32:35], a[184:187], v[140:143], v[32:35]
  v_mfma_f32_16x16x32_bf16 v[36:39], a[188:191], v[140:143], v[36:39]
  s_waitcnt vmcnt(13)
  v_mfma_f32_16x16x32_bf16 v[24:27], a[192:195], v[144:147], v[24:27]
  v_mfma_f32_16x16x32_bf16 v[28:31], a[196:199], v[144:147], v[28:31]
  s_add_u32 s78, s78, 4096
  buffer_load_dwordx4 v[200:203], v2, s[32:35], s78 offen offset:0 sc1
  v_mfma_f32_16x16x32_bf16 v[32:35], a[200:203], v[144:147], v[32:35]
  v_mfma_f32_16x16x32_bf16 v[36:39], a[204:207], v[144:147], v[36:39]
  s_waitcnt vmcnt(13)
  v_mfma_f32_16x16x32_bf16 v[24:27], a[208:211], v[148:151], v[24:27]
  v_mfma_f32_16x16x32_bf16 v[28:31], a[212:215], v[148:151], v[28:31]
  buffer_load_dwordx4 v[204:207], v2, s[32:35], s78 offen offset:1024 sc1
  v_mfma_f32_16x16x32_bf16 v[32:35], a[216:219], v[148:151], v[32:35]
  v_mfma_f32_16x16x32_bf16 v[36:39], a[220:223], v[148:151], v[36:39]
  s_waitcnt vmcnt(13)
  v_mfma_f32_16x16x32_bf16 v[8:11], a[0:3], v[152:155], 0
  v_mfma_f32_16x16x32_bf16 v[12:15], a[4:7], v[152:155], 0
  buffer_load_dwordx4 v[40:43], v2, s[32:35], s79 offen offset:0 sc1
  v_mfma_f32_16x16x32_bf16 v[16:19], a[8:11], v[152:155], 0
  v_mfma_f32_16x16x32_bf16 v[20:23], a[12:15], v[152:155], 0
  s_waitcnt vmcnt(13)
  v_mfma_f32_16x16x32_bf16 v[8:11], a[16:19], v[156:159], v[8:11]
  v_mfma_f32_16x16x32_bf16 v[12:15], a[20:23], v[156:159], v[12:15]
  buffer_load_dwordx4 v[44:47], v2, s[32:35], s79 offen offset:1024 sc1
  v_mfma_f32_16x16x32_bf16 v[16:19], a[24:27], v[156:159], v[16:19]
  v_mfma_f32_16x16x32_bf16 v[20:23], a[28:31], v[156:159], v[20:23]
  ds_write_b128 v6, v[24:27] offset:0
  s_waitcnt vmcnt(13)
  v_mfma_f32_16x16x32_bf16 v[8:11], a[32:35], v[160:163], v[8:11]
  v_mfma_f32_16x16x32_bf16 v[12:15], a[36:39], v[160:163], v[12:15]
  buffer_load_dwordx4 v[48:51], v2, s[32:35], s79 offen offset:2048 sc1
  v_mfma_f32_16x16x32_bf16 v[16:19], a[40:43], v[160:163], v[16:19]
  v_mfma_f32_16x16x32_bf16 v[20:23], a[44:47], v[160:163], v[20:23]
  ds_write_b128 v6, v[28:31] offset:1024
  s_waitcnt vmcnt(13)
  v_mfma_f32_16x16x32_bf16 v[8:11], a[48:51], v[164:167], v[8:11]
  v_mfma_f32_16x16x32_bf16 v[12:15], a[52:55], v[164:167], v[12:15]
  buffer_load_dwordx4 v[52:55], v2, s[32:35], s79 offen offset:3072 sc1
  v_mfma_f32_16x16x32_bf16 v[16:19], a[56:59], v[164:167], v[16:19]
  v_mfma_f32_16x16x32_bf16 v[20:23], a[60:63], v[164:167], v[20:23]
  ds_write_b128 v6, v[32:35] offset:2048
  s_waitcnt vmcnt(13)
  v_mfma_f32_16x16x32_bf16 v[8:11], a[64:67], v[168:171], v[8:11]
  v_mfma_f32_16x16x32_bf16 v[12:15], a[68:71], v[168:171], v[12:15]
  s_add_u32 s79, s79, 4096
  buffer_load_dwordx4 v[56:59], v2, s[32:35], s79 offen offset:0 sc1
  v_mfma_f32_16x16x32_bf16 v[16:19], a[72:75], v[168:171], v[16:19]
  v_mfma_f32_16x16x32_bf16 v[20:23], a[76:79], v[168:171], v[20:23]
  ds_write_b128 v6, v[36:39] offset:3072
  s_waitcnt vmcnt(13)
  v_mfma_f32_16x16x32_bf16 v[8:11], a[80:83], v[172:175], v[8:11]
  v_mfma_f32_16x16x32_bf16 v[12:15], a[84:87], v[172:175], v[12:15]
  buffer_load_dwordx4 v[60:63], v2, s[32:35], s79 offen offset:1024 sc1
  v_mfma_f32_16x16x32_bf16 v[16:19], a[88:91], v[172:175], v[16:19]
  v_mfma_f32_16x16x32_bf16 v[20:23], a[92:95], v[172:175], v[20:23]
  s_waitcnt vmcnt(13)
  v_mfma_f32_16x16x32_bf16 v[8:11], a[96:99], v[176:179], v[8:11]
  v_mfma_f32_16x16x32_bf16 v[12:15], a[100:103], v[176:179], v[12:15]
  buffer_load_dwordx4 v[64:67], v2, s[32:35], s79 offen offset:2048 sc1
  v_mfma_f32_16x16x32_bf16 v[16:19], a[104:107], v[176:179], v[16:19]
  v_mfma_f32_16x16x32_bf16 v[20:23], a[108:111], v[176:179], v[20:23]
  s_waitcnt vmcnt(13)
  v_mfma_f32_16x16x32_bf16 v[8:11], a[112:115], v[180:183], v[8:11]
  v_mfma_f32_16x16x32_bf16 v[12:15], a[116:119], v[180:183], v[12:15]
  buffer_load_dwordx4 v[68:71], v2, s[32:35], s79 offen offset:3072 sc1
  v_mfma_f32_16x16x32_bf16 v[16:19], a[120:123], v[180:183], v[16:19]
  v_mfma_f32_16x16x32_bf16 v[20:23], a[124:127], v[180:183], v[20:23]
  s_waitcnt vmcnt(13)
  v_mfma_f32_16x16x32_bf16 v[8:11], a[128:131], v[184:187], v[8:11]
  v_mfma_f32_16x16x32_bf16 v[12:15], a[132:135], v[184:187], v[12:15]
  s_add_u32 s79, s79, 4096
  buffer_load_dwordx4 v[72:75], v2, s[32:35], s79 offen offset:0 sc1
  v_mfma_f32_16x16x32_bf16 v[16:19], a[136:139], v[184:187], v[16:19]
  v_mfma_f32_16x16x32_bf16 v[20:23], a[140:143], v[184:187], v[20:23]
  s_waitcnt vmcnt(13)
  v_mfma_f32_16x16x32_bf16 v[8:11], a[144:147], v[188:191], v[8:11]
  v_mfma_f32_16x16x32_bf16 v[12:15], a[148:151], v[188:191], v[12:15]
  buffer_load_dwordx4 v[76:79], v2, s[32:35], s79 offen offset:1024 sc1
  v_mfma_f32_16x16x32_bf16 v[16:19], a[152:155], v[188:191], v[16:19]
  v_mfma_f32_16x16x32_bf16 v[20:23], a[156:159], v[188:191], v[20:23]
  s_waitcnt vmcnt(13)
  v_mfma_f32_16x16x32_bf16 v[8:11], a[160:163], v[192:195], v[8:11]
  v_mfma_f32_16x16x32_bf16 v[12:15], a[164:167], v[192:195], v[12:15]
  buffer_load_dwordx4 v[80:83], v2, s[32:35], s79 offen offset:2048 sc1
  v_mfma_f32_16x16x32_bf16 v[16:19], a[168:171], v[192:195], v[16:19]
  v_mfma_f32_16x16x32_bf16 v[20:23], a[172:175], v[192:195], v[20:23]
  s_waitcnt vmcnt(13)
  v_mfma_f32_16x16x32_bf16 v[8:11], a[176:179], v[196:199], v[8:11]
  v_mfma_f32_16x16x32_bf16 v[12:15], a[180:183], v[196:199], v[12:15]
  buffer_load_dwordx4 v[84:87], v2, s[32:35], s79 offen offset:3072 sc1
  v_mfma_f32_16x16x32_bf16 v[16:19], a[184:187], v[196:199], v[16:19]
  v_mfma_f32_16x16x32_bf16 v[20:23], a[188:191], v[196:199], v[20:23]
  s_waitcnt vmcnt(13)
  v_mfma_f32_16x16x32_bf16 v[8:11], a[192:195], v[200:203], v[8:11]
  v_mfma_f32_16x16x32_bf16 v[12:15], a[196:199], v[200:203], v[12:15]
  s_add_u32 s79, s79, 4096
  buffer_load_dwordx4 v[88:91], v2, s[32:35], s79 offen offset:0 sc1
  v_mfma_f32_16x16x32_bf16 v[16:19], a[200:203], v[200:203], v[16:19]
  v_mfma_f32_16x16x32_bf16 v[20:23], a[204:207], v[200:203], v[20:23]
  s_waitcnt vmcnt(13)
  v_mfma_f32_16x16x32_bf16 v[8:11], a[208:211], v[204:207], v[8:11]
  v_mfma_f32_16x16x32_bf16 v[12:15], a[212:215], v[204:207], v[12:15]
  buffer_load_dwordx4 v[92:95], v2, s[32:35], s79 offen offset:1024 sc1
  v_mfma_f32_16x16x32_bf16 v[16:19], a[216:219], v[204:207], v[16:19]
  v_mfma_f32_16x16x32_bf16 v[20:23], a[220:223], v[204:207], v[20:23]
  s_waitcnt vmcnt(13)
  v_mfma_f32_16x16x32_bf16 v[24:27], a[0:3], v[40:43], 0
  v_mfma_f32_16x16x32_bf16 v[28:31], a[4:7], v[40:43], 0
  v_mfma_f32_16x16x32_bf16 v[32:35], a[8:11], v[40:43], 0
  v_mfma_f32_16x16x32_bf16 v[36:39], a[12:15], v[40:43], 0
  s_waitcnt vmcnt(12)
  v_mfma_f32_16x16x32_bf16 v[24:27], a[16:19], v[44:47], v[24:27]
  v_mfma_f32_16x16x32_bf16 v[28:31], a[20:23], v[44:47], v[28:31]
  v_mfma_f32_16x16x32_bf16 v[32:35], a[24:27], v[44:47], v[32:35]
  v_mfma_f32_16x16x32_bf16 v[36:39], a[28:31], v[44:47], v[36:39]
  ds_write_b128 v7, v[8:11] offset:0
  s_waitcnt vmcnt(11)
  v_mfma_f32_16x16x32_bf16 v[24:27], a[32:35], v[48:51], v[24:27]
  v_mfma_f32_16x16x32_bf16 v[28:31], a[36:39], v[48:51], v[28:31]
  v_mfma_f32_16x16x32_bf16 v[32:35], a[40:43], v[48:51], v[32:35]
  v_mfma_f32_16x16x32_bf16 v[36:39], a[44:47], v[48:51], v[36:39]
  ds_write_b128 v7, v[12:15] offset:1024
  s_waitcnt vmcnt(10)
  v_mfma_f32_16x16x32_bf16 v[24:27], a[48:51], v[52:55], v[24:27]
  v_mfma_f32_16x16x32_bf16 v[28:31], a[52:55], v[52:55], v[28:31]
  v_mfma_f32_16x16x32_bf16 v[32:35], a[56:59], v[52:55], v[32:35]
  v_mfma_f32_16x16x32_bf16 v[36:39], a[60:63], v[52:55], v[36:39]
  ds_write_b128 v7, v[16:19] offset:2048
  s_waitcnt vmcnt(9)
  v_mfma_f32_16x16x32_bf16 v[24:27], a[64:67], v[56:59], v[24:27]
  v_mfma_f32_16x16x32_bf16 v[28:31], a[68:71], v[56:59], v[28:31]
  v_mfma_f32_16x16x32_bf16 v[32:35], a[72:75], v[56:59], v[32:35]
  v_mfma_f32_16x16x32_bf16 v[36:39], a[76:79], v[56:59], v[36:39]
  ds_write_b128 v7, v[20:23] offset:3072
  s_waitcnt vmcnt(8)
  v_mfma_f32_16x16x32_bf16 v[24:27], a[80:83], v[60:63], v[24:27]
  v_mfma_f32_16x16x32_bf16 v[28:31], a[84:87], v[60:63], v[28:31]
  v_mfma_f32_16x16x32_bf16 v[32:35], a[88:91], v[60:63], v[32:35]
  v_mfma_f32_16x16x32_bf16 v[36:39], a[92:95], v[60:63], v[36:39]
  s_waitcnt vmcnt(7)
  v_mfma_f32_16x16x32_bf16 v[24:27], a[96:99], v[64:67], v[24:27]
  v_mfma_f32_16x16x32_bf16 v[28:31], a[100:103], v[64:67], v[28:31]
  v_mfma_f32_16x16x32_bf16 v[32:35], a[104:107], v[64:67], v[32:35]
  v_mfma_f32_16x16x32_bf16 v[36:39], a[108:111], v[64:67], v[36:39]
  s_waitcnt vmcnt(6)
  v_mfma_f32_16x16x32_bf16 v[24:27], a[112:115], v[68:71], v[24:27]
  v_mfma_f32_16x16x32_bf16 v[28:31], a[116:119], v[68:71], v[28:31]
  v_mfma_f32_16x16x32_bf16 v[32:35], a[120:123], v[68:71], v[32:35]
  v_mfma_f32_16x16x32_bf16 v[36:39], a[124:127], v[68:71], v[36:39]
  s_waitcnt vmcnt(5)
  v_mfma_f32_16x16x32_bf16 v[24:27], a[128:131], v[72:75], v[24:27]
  v_mfma_f32_16x16x32_bf16 v[28:31], a[132:135], v[72:75], v[28:31]
  v_mfma_f32_16x16x32_bf16 v[32:35], a[136:139], v[72:75], v[32:35]
  v_mfma_f32_16x16x32_bf16 v[36:39], a[140:143], v[72:75], v[36:39]
  s_waitcnt vmcnt(4)
  v_mfma_f32_16x16x32_bf16 v[24:27], a[144:147], v[76:79], v[24:27]
  v_mfma_f32_16x16x32_bf16 v[28:31], a[148:151], v[76:79], v[28:31]
  v_mfma_f32_16x16x32_bf16 v[32:35], a[152:155], v[76:79], v[32:35]
  v_mfma_f32_16x16x32_bf16 v[36:39], a[156:159], v[76:79], v[36:39]
  s_waitcnt vmcnt(3)
  v_mfma_f32_16x16x32_bf16 v[24:27], a[160:163], v[80:83], v[24:27]
  v_mfma_f32_16x16x32_bf16 v[28:31], a[164:167], v[80:83], v[28:31]
  v_mfma_f32_16x16x32_bf16 v[32:35], a[168:171], v[80:83], v[32:35]
  v_mfma_f32_16x16x32_bf16 v[36:39], a[172:175], v[80:83], v[36:39]
  s_waitcnt vmcnt(2)
  v_mfma_f32_16x16x32_bf16 v[24:27], a[176:179], v[84:87], v[24:27]
  v_mfma_f32_16x16x32_bf16 v[28:31], a[180:183], v[84:87], v[28:31]
  v_mfma_f32_16x16x32_bf16 v[32:35], a[184:187], v[84:87], v[32:35]
  v_mfma_f32_16x16x32_bf16 v[36:39], a[188:191], v[84:87], v[36:39]
  s_waitcnt vmcnt(1)
  v_mfma_f32_16x16x32_bf16 v[24:27], a[192:195], v[88:91], v[24:27]
  v_mfma_f32_16x16x32_bf16 v[28:31], a[196:199], v[88:91], v[28:31]
  v_mfma_f32_16x16x32_bf16 v[32:35], a[200:203], v[88:91], v[32:35]
  v_mfma_f32_16x16x32_bf16 v[36:39], a[204:207], v[88:91], v[36:39]
  s_waitcnt vmcnt(0)
  v_mfma_f32_16x16x32_bf16 v[24:27], a[208:211], v[92:95], v[24:27]
  v_mfma_f32_16x16x32_bf16 v[28:31], a[212:215], v[92:95], v[28:31]
  v_mfma_f32_16x16x32_bf16 v[32:35], a[216:219], v[92:95], v[32:35]
  v_mfma_f32_16x16x32_bf16 v[36:39], a[220:223], v[92:95], v[36:39]
  v_lshlrev_b32 v88, 16, v216
  v_and_b32 v89, s92, v216
  v_lshlrev_b32 v90, 16, v217
  v_and_b32 v91, s92, v217
  v_lshlrev_b32 v92, 16, v218
  v_and_b32 v93, s92, v218
  v_lshlrev_b32 v94, 16, v219
  v_and_b32 v95, s92, v219
  v_lshlrev_b32 v96, 16, v220
  v_and_b32 v97, s92, v220
  v_lshlrev_b32 v98, 16, v221
  v_and_b32 v99, s92, v221
  v_lshlrev_b32 v100, 16, v222
  v_and_b32 v101, s92, v222
  v_lshlrev_b32 v102, 16, v223
  v_and_b32 v103, s92, v223
  s_waitcnt lgkmcnt(0)
  s_barrier
  ds_read_b128 v[40:43], v4 offset:0
  ds_read_b128 v[44:47], v4 offset:1024
  ds_read_b128 v[48:51], v4 offset:2048
  ds_read_b128 v[52:55], v4 offset:3072
  ds_read_b128 v[56:59], v4 offset:4096
  ds_read_b128 v[60:63], v4 offset:5120
  ds_read_b128 v[64:67], v4 offset:6144
  ds_read_b128 v[68:71], v4 offset:7168
  ds_read_b128 v[72:75], v4 offset:8192
  ds_read_b128 v[76:79], v4 offset:9216
  ds_read_b128 v[80:83], v4 offset:10240
  ds_read_b128 v[84:87], v4 offset:11264
  v_pk_add_f32 v[24:25], v[24:25], v[88:89]
  v_pk_add_f32 v[26:27], v[26:27], v[90:91]
  v_pk_add_f32 v[28:29], v[28:29], v[92:93]
  v_pk_add_f32 v[30:31], v[30:31], v[94:95]
  v_pk_add_f32 v[32:33], v[32:33], v[96:97]
  v_pk_add_f32 v[34:35], v[34:35], v[98:99]
  v_pk_add_f32 v[36:37], v[36:37], v[100:101]
  v_pk_add_f32 v[38:39], v[38:39], v[102:103]
  s_waitcnt lgkmcnt(8)
  v_pk_add_f32 v[24:25], v[24:25], v[40:41]
  v_pk_add_f32 v[26:27], v[26:27], v[42:43]
  v_pk_add_f32 v[28:29], v[28:29], v[44:45]
  v_pk_add_f32 v[30:31], v[30:31], v[46:47]
  v_pk_add_f32 v[32:33], v[32:33], v[48:49]
  v_pk_add_f32 v[34:35], v[34:35], v[50:51]
  v_pk_add_f32 v[36:37], v[36:37], v[52:53]
  v_pk_add_f32 v[38:39], v[38:39], v[54:55]
  s_waitcnt lgkmcnt(4)
  v_pk_add_f32 v[24:25], v[24:25], v[56:57]
  v_pk_add_f32 v[26:27], v[26:27], v[58:59]
  v_pk_add_f32 v[28:29], v[28:29], v[60:61]
  v_pk_add_f32 v[30:31], v[30:31], v[62:63]
  v_pk_add_f32 v[32:33], v[32:33], v[64:65]
  v_pk_add_f32 v[34:35], v[34:35], v[66:67]
  v_pk_add_f32 v[36:37], v[36:37], v[68:69]
  v_pk_add_f32 v[38:39], v[38:39], v[70:71]
  s_waitcnt lgkmcnt(0)
  v_pk_add_f32 v[24:25], v[24:25], v[72:73]
  v_pk_add_f32 v[26:27], v[26:27], v[74:75]
  v_pk_add_f32 v[28:29], v[28:29], v[76:77]
  v_pk_add_f32 v[30:31], v[30:31], v[78:79]
  v_pk_add_f32 v[32:33], v[32:33], v[80:81]
  v_pk_add_f32 v[34:35], v[34:35], v[82:83]
  v_pk_add_f32 v[36:37], v[36:37], v[84:85]
  v_pk_add_f32 v[38:39], v[38:39], v[86:87]
  v_cvt_pk_bf16_f32 v40, v24, v25
  v_cvt_pk_bf16_f32 v41, v26, v27
  v_cvt_pk_bf16_f32 v42, v28, v29
  v_cvt_pk_bf16_f32 v43, v30, v31
  v_cvt_pk_bf16_f32 v44, v32, v33
  v_cvt_pk_bf16_f32 v45, v34, v35
  v_cvt_pk_bf16_f32 v46, v36, v37
  v_cvt_pk_bf16_f32 v47, v38, v39
  v_lshrrev_b32 v4, 4, v1
  v_lshlrev_b32 v4, 11, v4
  v_and_b32 v5, 15, v1
  v_lshl_add_u32 v4, v5, 4, v4
  s_lshl_b32 s59, s4, 19
  s_lshl_b32 s60, s95, 17
  s_add_u32 s59, s59, s60
  s_lshl_b32 s60, s6, 15
  s_add_u32 s59, s59, s60
  s_lshl_b32 s60, s96, 8
  s_add_u32 s59, s59, s60
  s_add_u32 s59, s59, s84
  s_add_u32 s60, s59, 8192
  s_add_u32 s61, s59, 16384
  s_add_u32 s58, s59, 24576
  s_mul_i32 s62, s6, 12288
  s_add_u32 s62, s62, 114688
  v_lshlrev_b32 v6, 5, v1
  v_add_u32 v6, s62, v6
  ds_write_b128 v6, v[40:43]
  ds_write_b128 v6, v[44:47] offset:16
  v_bfe_u32 v7, v1, 2, 2
  v_lshlrev_b32 v7, 9, v7
  v_lshrrev_b32 v6, 4, v1
  v_lshl_add_u32 v7, v6, 5, v7
  v_and_b32 v6, 3, v1
  v_lshl_add_u32 v7, v6, 3, v7
  v_add_u32 v7, s62, v7
  ds_read_b64 v[224:225], v7 offset:0
  ds_read_b64 v[228:229], v7 offset:128
  ds_read_b64 v[232:233], v7 offset:256
  ds_read_b64 v[236:237], v7 offset:384
  s_waitcnt lgkmcnt(0)
  s_cmp_eq_u32 s100, 1
  s_cbranch_scc1 L_stp_43
  buffer_store_dwordx4 v[224:227], v4, s[32:35], s59 offen sc1
  buffer_store_dwordx4 v[228:231], v4, s[32:35], s60 offen sc1
  buffer_store_dwordx4 v[232:235], v4, s[32:35], s61 offen sc1
  buffer_store_dwordx4 v[236:239], v4, s[32:35], s58 offen sc1
  s_branch L_std_44
L_stp_43:
  buffer_store_dwordx4 v[224:227], v4, s[32:35], s59 offen
  buffer_store_dwordx4 v[228:231], v4, s[32:35], s60 offen
  buffer_store_dwordx4 v[232:235], v4, s[32:35], s61 offen
  buffer_store_dwordx4 v[236:239], v4, s[32:35], s58 offen
L_std_44:
  s_cmp_eq_u32 s100, 1
  s_cbranch_scc1 L_keepbuf
  s_add_u32 s54, s54, 2097152
  s_mov_b32 s72, 29360128
L_keepbuf:
  v_lshlrev_b32 v2, 4, v1
  s_lshl_b32 s57, s52, 14
  s_add_u32 s57, s57, s84
  s_lshl_b32 s58, s6, 12
  s_add_u32 s57, s57, s58
  v_accvgpr_read_b32 v48, a224
  v_accvgpr_read_b32 v56, a232
  v_accvgpr_read_b32 v49, a225
  v_accvgpr_read_b32 v57, a233
  v_accvgpr_read_b32 v50, a226
  v_accvgpr_read_b32 v58, a234
  v_accvgpr_read_b32 v51, a227
  v_accvgpr_read_b32 v59, a235
  v_accvgpr_read_b32 v52, a228
  v_accvgpr_read_b32 v60, a236
  v_accvgpr_read_b32 v53, a229
  v_accvgpr_read_b32 v61, a237
  v_accvgpr_read_b32 v54, a230
  v_accvgpr_read_b32 v62, a238
  v_accvgpr_read_b32 v55, a231
  v_accvgpr_read_b32 v63, a239
  v_lshlrev_b32 v16, 16, v48
  v_and_b32 v17, s92, v48
  v_lshlrev_b32 v32, 16, v56
  v_and_b32 v33, s92, v56
  v_lshlrev_b32 v18, 16, v49
  v_and_b32 v19, s92, v49
  v_lshlrev_b32 v34, 16, v57
  v_and_b32 v35, s92, v57
  v_lshlrev_b32 v20, 16, v50
  v_and_b32 v21, s92, v50
  v_lshlrev_b32 v36, 16, v58
  v_and_b32 v37, s92, v58
  v_lshlrev_b32 v22, 16, v51
  v_and_b32 v23, s92, v51
  v_lshlrev_b32 v38, 16, v59
  v_and_b32 v39, s92, v59
  v_lshlrev_b32 v24, 16, v52
  v_and_b32 v25, s92, v52
  v_lshlrev_b32 v40, 16, v60
  v_and_b32 v41, s92, v60
  v_lshlrev_b32 v26, 16, v53
  v_and_b32 v27, s92, v53
  v_lshlrev_b32 v42, 16, v61
  v_and_b32 v43, s92, v61
  v_lshlrev_b32 v28, 16, v54
  v_and_b32 v29, s92, v54
  v_lshlrev_b32 v44, 16, v62
  v_and_b32 v45, s92, v62
  v_lshlrev_b32 v30, 16, v55
  v_and_b32 v31, s92, v55
  v_lshlrev_b32 v46, 16, v63
  v_and_b32 v47, s92, v63
  s_mul_i32 s62, s6, 12288
  s_add_u32 s62, s62, 114688
  v_lshlrev_b32 v76, 3, v1
  v_add_u32 v76, s62, v76
  v_lshlrev_b32 v77, 5, v1
  v_add_u32 v77, s62, v77
  v_bfe_u32 v72, v0, 2, 3
  v_lshlrev_b32 v73, 7, v72
  v_lshlrev_b32 v72, 11, v72
  v_and_b32 v74, 3, v0
  v_lshl_add_u32 v72, v74, 8, v72
  v_lshl_add_u32 v73, v74, 4, v73
  v_lshrrev_b32 v74, 5, v0
  v_lshl_add_u32 v72, v74, 4, v72
  v_lshl_add_u32 v73, v74, 10, v73
  s_lshr_b32 s76, s5, 1
  s_lshl_b32 s76, s76, 14
  s_and_b32 s77, s5, 1
  s_lshl_b32 s77, s77, 7
  s_add_u32 s76, s76, s77
  s_add_u32 s76, s76, s54
  s_lshl_b32 s77, s5, 13
  s_add_u32 s77, s77, s85
  s_mov_b32 s56, 262144
  buffer_load_dwordx4 v[80:83], v2, s[32:35], s57 offen offset:0 sc1
  buffer_load_dwordx4 v[84:87], v2, s[32:35], s57 offen offset:1024 sc1
  buffer_load_dwordx4 v[88:91], v2, s[32:35], s57 offen offset:2048 sc1
  buffer_load_dwordx4 v[92:95], v2, s[32:35], s57 offen offset:3072 sc1
  s_waitcnt vmcnt(3)
L_tq_45:
  v_cmp_ne_u64 vcc, s[98:99], v[82:83]
  s_cbranch_vccz L_tqn_46
  s_sub_u32 s56, s56, 1
  s_cbranch_scc1 L_tqt_47
  s_sleep 1
  buffer_load_dwordx4 v[80:83], v2, s[32:35], s57 offen offset:0 sc1
  s_waitcnt vmcnt(0)
  s_branch L_tq_45
L_tqt_47:
L_tqn_46:
  s_waitcnt vmcnt(2)
L_tq_48:
  v_cmp_ne_u64 vcc, s[98:99], v[86:87]
  s_cbranch_vccz L_tqn_49
  s_sub_u32 s56, s56, 1
  s_cbranch_scc1 L_tqt_50
  s_sleep 1
  buffer_load_dwordx4 v[84:87], v2, s[32:35], s57 offen offset:1024 sc1
  s_waitcnt vmcnt(0)
  s_branch L_tq_48
L_tqt_50:
L_tqn_49:
  s_waitcnt vmcnt(1)
L_tq_51:
  v_cmp_ne_u64 vcc, s[98:99], v[90:91]
  s_cbranch_vccz L_tqn_52
  s_sub_u32 s56, s56, 1
  s_cbranch_scc1 L_tqt_53
  s_sleep 1
  buffer_load_dwordx4 v[88:91], v2, s[32:35], s57 offen offset:2048 sc1
  s_waitcnt vmcnt(0)
  s_branch L_tq_51
L_tqt_53:
L_tqn_52:
  s_waitcnt vmcnt(0)
L_tq_54:
  v_cmp_ne_u64 vcc, s[98:99], v[94:95]
  s_cbranch_vccz L_tqn_55
  s_sub_u32 s56, s56, 1
  s_cbranch_scc1 L_tqt_56
  s_sleep 1
  buffer_load_dwordx4 v[92:95], v2, s[32:35], s57 offen offset:3072 sc1
  s_waitcnt vmcnt(0)
  s_branch L_tq_54
L_tqt_56:
L_tqn_55:
  ds_write_b64 v76, v[80:81] offset:0
  ds_write_b64 v76, v[84:85] offset:512
  ds_write_b64 v76, v[88:89] offset:1024
  ds_write_b64 v76, v[92:93] offset:1536
  ds_read_b128 v[64:67], v77
  ds_read_b128 v[68:71], v77 offset:16
  s_waitcnt lgkmcnt(0)
  v_lshlrev_b32 v48, 16, v64
  v_and_b32 v49, s92, v64
  v_lshlrev_b32 v50, 16, v65
  v_and_b32 v51, s92, v65
  v_lshlrev_b32 v52, 16, v66
  v_and_b32 v53, s92, v66
  v_lshlrev_b32 v54, 16, v67
  v_and_b32 v55, s92, v67
  v_lshlrev_b32 v56, 16, v68
  v_and_b32 v57, s92, v68
  v_lshlrev_b32 v58, 16, v69
  v_and_b32 v59, s92, v69
  v_lshlrev_b32 v60, 16, v70
  v_and_b32 v61, s92, v70
  v_lshlrev_b32 v62, 16, v71
  v_and_b32 v63, s92, v71
  v_pk_add_f32 v[16:17], v[16:17], v[48:49]
  v_pk_add_f32 v[18:19], v[18:19], v[50:51]
  v_pk_add_f32 v[20:21], v[20:21], v[52:53]
  v_pk_add_f32 v[22:23], v[22:23], v[54:55]
  v_pk_add_f32 v[24:25], v[24:25], v[56:57]
  v_pk_add_f32 v[26:27], v[26:27], v[58:59]
  v_pk_add_f32 v[28:29], v[28:29], v[60:61]
  v_pk_add_f32 v[30:31], v[30:31], v[62:63]
  v_pk_add_f32 v[8:9], v[16:17], v[18:19]
  v_pk_mul_f32 v[10:11], v[16:17], v[16:17]
  v_pk_add_f32 v[12:13], v[20:21], v[22:23]
  v_pk_mul_f32 v[14:15], v[18:19], v[18:19]
  v_pk_add_f32 v[8:9], v[8:9], v[24:25]
  v_pk_fma_f32 v[10:11], v[20:21], v[20:21], v[10:11]
  v_pk_add_f32 v[12:13], v[12:13], v[26:27]
  v_pk_fma_f32 v[14:15], v[22:23], v[22:23], v[14:15]
  v_pk_add_f32 v[8:9], v[8:9], v[28:29]
  v_pk_fma_f32 v[10:11], v[24:25], v[24:25], v[10:11]
  v_pk_add_f32 v[12:13], v[12:13], v[30:31]
  v_pk_fma_f32 v[14:15], v[26:27], v[26:27], v[14:15]
  v_pk_fma_f32 v[10:11], v[28:29], v[28:29], v[10:11]
  v_pk_fma_f32 v[14:15], v[30:31], v[30:31], v[14:15]
  v_pk_add_f32 v[8:9], v[8:9], v[12:13]
  v_pk_add_f32 v[10:11], v[10:11], v[14:15]
  v_add_f32 v4, v8, v9
  v_add_f32 v5, v10, v11
  s_nop 0
  v_add_f32_dpp v4, v4, v4 row_ror:8 row_mask:0xf bank_mask:0xf
  v_add_f32_dpp v5, v5, v5 row_ror:8 row_mask:0xf bank_mask:0xf
  s_nop 0
  v_add_f32_dpp v4, v4, v4 row_ror:4 row_mask:0xf bank_mask:0xf
  v_add_f32_dpp v5, v5, v5 row_ror:4 row_mask:0xf bank_mask:0xf
  s_nop 0
  v_add_f32_dpp v4, v4, v4 row_ror:2 row_mask:0xf bank_mask:0xf
  v_add_f32_dpp v5, v5, v5 row_ror:2 row_mask:0xf bank_mask:0xf
  s_nop 0
  v_add_f32_dpp v4, v4, v4 row_ror:1 row_mask:0xf bank_mask:0xf
  v_add_f32_dpp v5, v5, v5 row_ror:1 row_mask:0xf bank_mask:0xf
  v_mov_b32 v6, v4
  v_mov_b32 v7, v5
  s_nop 0
  v_permlane16_swap_b32 v4, v6
  v_permlane16_swap_b32 v5, v7
  v_add_f32 v4, v4, v6
  v_add_f32 v5, v5, v7
  v_mul_f32 v4, 0x3b000000, v4
  v_mul_f32 v5, 0x3b000000, v5
  v_fma_f32 v5, -v4, v4, v5
  v_max_f32 v5, 0, v5
  v_add_f32 v5, s97, v5
  v_rsq_f32 v6, v5
  s_nop 0
  v_mul_f32 v8, v4, v6
  v_pk_fma_f32 v[48:49], v[16:17], v[6:7], v[8:9] op_sel_hi:[1,0,0] neg_lo:[0,0,1] neg_hi:[0,0,1]
  v_pk_fma_f32 v[50:51], v[18:19], v[6:7], v[8:9] op_sel_hi:[1,0,0] neg_lo:[0,0,1] neg_hi:[0,0,1]
  v_pk_fma_f32 v[52:53], v[20:21], v[6:7], v[8:9] op_sel_hi:[1,0,0] neg_lo:[0,0,1] neg_hi:[0,0,1]
  v_pk_fma_f32 v[54:55], v[22:23], v[6:7], v[8:9] op_sel_hi:[1,0,0] neg_lo:[0,0,1] neg_hi:[0,0,1]
  v_pk_fma_f32 v[56:57], v[24:25], v[6:7], v[8:9] op_sel_hi:[1,0,0] neg_lo:[0,0,1] neg_hi:[0,0,1]
  v_pk_fma_f32 v[58:59], v[26:27], v[6:7], v[8:9] op_sel_hi:[1,0,0] neg_lo:[0,0,1] neg_hi:[0,0,1]
  v_pk_fma_f32 v[60:61], v[28:29], v[6:7], v[8:9] op_sel_hi:[1,0,0] neg_lo:[0,0,1] neg_hi:[0,0,1]
  v_pk_fma_f32 v[62:63], v[30:31], v[6:7], v[8:9] op_sel_hi:[1,0,0] neg_lo:[0,0,1] neg_hi:[0,0,1]
  v_pk_fma_f32 v[16:17], v[48:49], v[32:33], v[16:17]
  v_pk_fma_f32 v[18:19], v[50:51], v[34:35], v[18:19]
  v_pk_fma_f32 v[20:21], v[52:53], v[36:37], v[20:21]
  v_pk_fma_f32 v[22:23], v[54:55], v[38:39], v[22:23]
  v_pk_fma_f32 v[24:25], v[56:57], v[40:41], v[24:25]
  v_pk_fma_f32 v[26:27], v[58:59], v[42:43], v[26:27]
  v_pk_fma_f32 v[28:29], v[60:61], v[44:45], v[28:29]
  v_pk_fma_f32 v[30:31], v[62:63], v[46:47], v[30:31]
  v_cvt_pk_bf16_f32 v48, v16, v17
  v_cvt_pk_bf16_f32 v49, v18, v19
  v_cvt_pk_bf16_f32 v50, v20, v21
  v_cvt_pk_bf16_f32 v51, v22, v23
  v_cvt_pk_bf16_f32 v52, v24, v25
  v_cvt_pk_bf16_f32 v53, v26, v27
  v_cvt_pk_bf16_f32 v54, v28, v29
  v_cvt_pk_bf16_f32 v55, v30, v31
  buffer_store_dwordx4 v[48:51], v73, s[32:35], s77 offen
  buffer_store_dwordx4 v[52:55], v73, s[32:35], s77 offen offset:64
  v_pk_add_f32 v[8:9], v[16:17], v[18:19]
  v_pk_mul_f32 v[10:11], v[16:17], v[16:17]
  v_pk_add_f32 v[12:13], v[20:21], v[22:23]
  v_pk_mul_f32 v[14:15], v[18:19], v[18:19]
  v_pk_add_f32 v[8:9], v[8:9], v[24:25]
  v_pk_fma_f32 v[10:11], v[20:21], v[20:21], v[10:11]
  v_pk_add_f32 v[12:13], v[12:13], v[26:27]
  v_pk_fma_f32 v[14:15], v[22:23], v[22:23], v[14:15]
  v_pk_add_f32 v[8:9], v[8:9], v[28:29]
  v_pk_fma_f32 v[10:11], v[24:25], v[24:25], v[10:11]
  v_pk_add_f32 v[12:13], v[12:13], v[30:31]
  v_pk_fma_f32 v[14:15], v[26:27], v[26:27], v[14:15]
  v_pk_fma_f32 v[10:11], v[28:29], v[28:29], v[10:11]
  v_pk_fma_f32 v[14:15], v[30:31], v[30:31], v[14:15]
  v_pk_add_f32 v[8:9], v[8:9], v[12:13]
  v_pk_add_f32 v[10:11], v[10:11], v[14:15]
  v_add_f32 v4, v8, v9
  v_add_f32 v5, v10, v11
  s_nop 0
  v_add_f32_dpp v4, v4, v4 row_ror:8 row_mask:0xf bank_mask:0xf
  v_add_f32_dpp v5, v5, v5 row_ror:8 row_mask:0xf bank_mask:0xf
  s_nop 0
  v_add_f32_dpp v4, v4, v4 row_ror:4 row_mask:0xf bank_mask:0xf
  v_add_f32_dpp v5, v5, v5 row_ror:4 row_mask:0xf bank_mask:0xf
  s_nop 0
  v_add_f32_dpp v4, v4, v4 row_ror:2 row_mask:0xf bank_mask:0xf
  v_add_f32_dpp v5, v5, v5 row_ror:2 row_mask:0xf bank_mask:0xf
  s_nop 0
  v_add_f32_dpp v4, v4, v4 row_ror:1 row_mask:0xf bank_mask:0xf
  v_add_f32_dpp v5, v5, v5 row_ror:1 row_mask:0xf bank_mask:0xf
  v_mov_b32 v6, v4
  v_mov_b32 v7, v5
  s_nop 0
  v_permlane16_swap_b32 v4, v6
  v_permlane16_swap_b32 v5, v7
  v_add_f32 v4, v4, v6
  v_add_f32 v5, v5, v7
  v_mul_f32 v4, 0x3b000000, v4
  v_mul_f32 v5, 0x3b000000, v5
  v_fma_f32 v5, -v4, v4, v5
  v_max_f32 v5, 0, v5
  v_add_f32 v6, s97, v5
  v_rsq_f32 v7, v6
  v_rcp_f32 v6, v6
  s_nop 0
  v_mul_f32 v6, v5, v6
  v_add_f32 v6, s97, v6
  v_rsq_f32 v6, v6
  s_nop 0
  v_mul_f32 v6, v7, v6
  v_mul_f32 v8, v4, v6
  v_pk_fma_f32 v[16:17], v[16:17], v[6:7], v[8:9] op_sel_hi:[1,0,0] neg_lo:[0,0,1] neg_hi:[0,0,1]
  v_pk_fma_f32 v[18:19], v[18:19], v[6:7], v[8:9] op_sel_hi:[1,0,0] neg_lo:[0,0,1] neg_hi:[0,0,1]
  v_pk_fma_f32 v[20:21], v[20:21], v[6:7], v[8:9] op_sel_hi:[1,0,0] neg_lo:[0,0,1] neg_hi:[0,0,1]
  v_pk_fma_f32 v[22:23], v[22:23], v[6:7], v[8:9] op_sel_hi:[1,0,0] neg_lo:[0,0,1] neg_hi:[0,0,1]
  v_pk_fma_f32 v[24:25], v[24:25], v[6:7], v[8:9] op_sel_hi:[1,0,0] neg_lo:[0,0,1] neg_hi:[0,0,1]
  v_pk_fma_f32 v[26:27], v[26:27], v[6:7], v[8:9] op_sel_hi:[1,0,0] neg_lo:[0,0,1] neg_hi:[0,0,1]
  v_pk_fma_f32 v[28:29], v[28:29], v[6:7], v[8:9] op_sel_hi:[1,0,0] neg_lo:[0,0,1] neg_hi:[0,0,1]
  v_pk_fma_f32 v[30:31], v[30:31], v[6:7], v[8:9] op_sel_hi:[1,0,0] neg_lo:[0,0,1] neg_hi:[0,0,1]
  v_cvt_pk_bf16_f32 v56, v16, v17
  v_cvt_pk_bf16_f32 v57, v18, v19
  v_cvt_pk_bf16_f32 v58, v20, v21
  v_cvt_pk_bf16_f32 v59, v22, v23
  v_cvt_pk_bf16_f32 v60, v24, v25
  v_cvt_pk_bf16_f32 v61, v26, v27
  v_cvt_pk_bf16_f32 v62, v28, v29
  v_cvt_pk_bf16_f32 v63, v30, v31
  buffer_store_dwordx4 v[56:59], v72, s[32:35], s76 offen
  buffer_store_dwordx4 v[60:63], v72, s[32:35], s76 offen offset:1024
  s_waitcnt vmcnt(0) lgkmcnt(0)
  s_cmp_eq_u32 s100, 1
  s_cbranch_scc1 L_sigp_58
  buffer_wbl2 sc1
  s_waitcnt vmcnt(0)
L_sigp_58:
  s_barrier
  s_cmp_lg_u32 s6, 0
  s_cbranch_scc1 L_sig_57
  s_lshl_b32 s57, s52, 2
  s_add_u32 s57, s57, 7168
  v_mov_b32 v2, s98
  s_mov_b64 exec, 1
  s_cmp_eq_u32 s100, 1
  s_cbranch_scc1 L_stp_59
  buffer_store_dword v2, off, s[32:35], s57 sc1
  s_branch L_std_60
L_stp_59:
  buffer_store_dword v2, off, s[32:35], s57
L_std_60:
  s_mov_b64 exec, -1
L_sig_57:
  v_lshrrev_b32 v2, 4, v1
  v_lshlrev_b32 v2, 3, v2
  s_mul_i32 s57, s94, 224
  buffer_load_dwordx2 v[64:65], v2, s[44:47], s57 offen offset:0
  buffer_load_dwordx2 v[66:67], v2, s[44:47], s57 offen offset:32
  buffer_load_dwordx2 v[68:69], v2, s[44:47], s57 offen offset:64
  buffer_load_dwordx2 v[70:71], v2, s[44:47], s57 offen offset:96
  buffer_load_dwordx2 v[72:73], v2, s[44:47], s57 offen offset:128
  buffer_load_dwordx2 v[74:75], v2, s[44:47], s57 offen offset:160
  buffer_load_dwordx2 v[76:77], v2, s[44:47], s57 offen offset:192
  s_waitcnt vmcnt(0)
  v_lshlrev_b32 v8, 16, v64
  v_and_b32 v9, s92, v64
  v_lshlrev_b32 v10, 16, v65
  v_and_b32 v11, s92, v65
  v_lshlrev_b32 v12, 16, v64
  v_and_b32 v13, s92, v64
  v_lshlrev_b32 v14, 16, v65
  v_and_b32 v15, s92, v65
  v_lshlrev_b32 v16, 16, v66
  v_and_b32 v17, s92, v66
  v_lshlrev_b32 v18, 16, v67
  v_and_b32 v19, s92, v67
  v_lshlrev_b32 v20, 16, v66
  v_and_b32 v21, s92, v66
  v_lshlrev_b32 v22, 16, v67
  v_and_b32 v23, s92, v67
  v_lshlrev_b32 v24, 16, v68
  v_and_b32 v25, s92, v68
  v_lshlrev_b32 v26, 16, v69
  v_and_b32 v27, s92, v69
  v_lshlrev_b32 v28, 16, v68
  v_and_b32 v29, s92, v68
  v_lshlrev_b32 v30, 16, v69
  v_and_b32 v31, s92, v69
  v_lshlrev_b32 v32, 16, v70
  v_and_b32 v33, s92, v70
  v_lshlrev_b32 v34, 16, v71
  v_and_b32 v35, s92, v71
  v_lshlrev_b32 v36, 16, v70
  v_and_b32 v37, s92, v70
  v_lshlrev_b32 v38, 16, v71
  v_and_b32 v39, s92, v71
  v_lshlrev_b32 v40, 16, v72
  v_and_b32 v41, s92, v72
  v_lshlrev_b32 v42, 16, v73
  v_and_b32 v43, s92, v73
  v_lshlrev_b32 v44, 16, v72
  v_and_b32 v45, s92, v72
  v_lshlrev_b32 v46, 16, v73
  v_and_b32 v47, s92, v73
  v_lshlrev_b32 v48, 16, v74
  v_and_b32 v49, s92, v74
  v_lshlrev_b32 v50, 16, v75
  v_and_b32 v51, s92, v75
  v_lshlrev_b32 v52, 16, v74
  v_and_b32 v53, s92, v74
  v_lshlrev_b32 v54, 16, v75
  v_and_b32 v55, s92, v75
  v_lshlrev_b32 v56, 16, v76
  v_and_b32 v57, s92, v76
  v_lshlrev_b32 v58, 16, v77
  v_and_b32 v59, s92, v77
  v_lshlrev_b32 v60, 16, v76
  v_and_b32 v61, s92, v76
  v_lshlrev_b32 v62, 16, v77
  v_and_b32 v63, s92, v77
  s_lshl_b32 s62, s4, 5
  s_lshl_b32 s61, s93, 4
  s_add_u32 s62, s62, s61
  s_lshl_b32 s61, s6, 2
  s_add_u32 s62, s62, s61
  s_lshl_b32 s57, s62, 2
  s_add_u32 s57, s57, 7168
  v_min_u32 v2, 3, v1
  v_lshlrev_b32 v2, 2, v2
  s_mov_b32 s56, 262144
L_poll_61:
  buffer_load_dword v3, v2, s[32:35], s57 offen sc1
  s_waitcnt vmcnt(0)
  v_cmp_ne_u32 vcc, s98, v3
  s_cbranch_vccz L_polld_62
  s_sub_u32 s56, s56, 1
  s_cbranch_scc1 L_polt_63
  s_sleep 1
  s_branch L_poll_61
L_polt_63:
L_polld_62:
  s_cmp_eq_u32 s100, 1
  s_cbranch_scc1 L_acq_64
  buffer_inv sc1
  s_waitcnt vmcnt(0)
L_acq_64:
  v_lshlrev_b32 v2, 4, v1
  s_lshl_b32 s57, s93, 17
  s_lshl_b32 s58, s6, 15
  s_add_u32 s57, s57, s58
  s_add_u32 s57, s57, s54
  s_add_u32 s58, s57, 16384
  buffer_load_dwordx4 v[120:123], v2, s[32:35], s57 offen offset:0 sc1
  buffer_load_dwordx4 v[124:127], v2, s[32:35], s58 offen offset:0 sc1
  buffer_load_dwordx4 v[128:131], v2, s[32:35], s57 offen offset:1024 sc1
  buffer_load_dwordx4 v[132:135], v2, s[32:35], s58 offen offset:1024 sc1
  buffer_load_dwordx4 v[136:139], v2, s[32:35], s57 offen offset:2048 sc1
  buffer_load_dwordx4 v[140:143], v2, s[32:35], s58 offen offset:2048 sc1
  buffer_load_dwordx4 v[144:147], v2, s[32:35], s57 offen offset:3072 sc1
  buffer_load_dwordx4 v[148:151], v2, s[32:35], s58 offen offset:3072 sc1
  s_add_u32 s57, s57, 4096
  s_add_u32 s58, s58, 4096
  v_lshrrev_b32 v3, 2, v1
  v_mul_u32_u24 v3, 224, v3
  v_and_b32 v4, 3, v1
  v_lshl_add_u32 v3, v4, 3, v3
  v_add_u32 v4, 57344, v3
  ds_read_b64_tr_b16 v[64:65], v3 offset:0
  ds_read_b64_tr_b16 v[66:67], v3 offset:3584
  ds_read_b64_tr_b16 v[68:69], v3 offset:32
  ds_read_b64_tr_b16 v[70:71], v3 offset:3616
  ds_read_b64_tr_b16 v[72:73], v3 offset:64
  ds_read_b64_tr_b16 v[74:75], v3 offset:3648
  ds_read_b64_tr_b16 v[76:77], v3 offset:96
  ds_read_b64_tr_b16 v[78:79], v3 offset:3680
  ds_read_b64_tr_b16 v[80:81], v3 offset:128
  ds_read_b64_tr_b16 v[82:83], v3 offset:3712
  ds_read_b64_tr_b16 v[84:85], v3 offset:160
  ds_read_b64_tr_b16 v[86:87], v3 offset:3744
  ds_read_b64_tr_b16 v[88:89], v3 offset:192
  ds_read_b64_tr_b16 v[90:91], v3 offset:3776
  s_waitcnt vmcnt(6) lgkmcnt(8)
  v_mfma_f32_16x16x32_bf16 v[8:11], v[64:67], v[120:123], v[8:11]
  ds_read_b64_tr_b16 v[92:93], v3 offset:7168
  v_mfma_f32_16x16x32_bf16 v[12:15], v[64:67], v[124:127], v[12:15]
  ds_read_b64_tr_b16 v[94:95], v3 offset:10752
  v_mfma_f32_16x16x32_bf16 v[16:19], v[68:71], v[120:123], v[16:19]
  ds_read_b64_tr_b16 v[96:97], v3 offset:7200
  buffer_load_dwordx4 v[152:155], v2, s[32:35], s57 offen offset:0 sc1
  v_mfma_f32_16x16x32_bf16 v[20:23], v[68:71], v[124:127], v[20:23]
  ds_read_b64_tr_b16 v[98:99], v3 offset:10784
  buffer_load_dwordx4 v[156:159], v2, s[32:35], s58 offen offset:0 sc1
  v_mfma_f32_16x16x32_bf16 v[24:27], v[72:75], v[120:123], v[24:27]
  ds_read_b64_tr_b16 v[100:101], v3 offset:7232
  v_mfma_f32_16x16x32_bf16 v[28:31], v[72:75], v[124:127], v[28:31]
  ds_read_b64_tr_b16 v[102:103], v3 offset:10816
  s_waitcnt lgkmcnt(10)
  v_mfma_f32_16x16x32_bf16 v[32:35], v[76:79], v[120:123], v[32:35]
  ds_read_b64_tr_b16 v[104:105], v3 offset:7264
  v_mfma_f32_16x16x32_bf16 v[36:39], v[76:79], v[124:127], v[36:39]
  ds_read_b64_tr_b16 v[106:107], v3 offset:10848
  v_mfma_f32_16x16x32_bf16 v[40:43], v[80:83], v[120:123], v[40:43]
  ds_read_b64_tr_b16 v[108:109], v3 offset:7296
  v_mfma_f32_16x16x32_bf16 v[44:47], v[80:83], v[124:127], v[44:47]
  ds_read_b64_tr_b16 v[110:111], v3 offset:10880
  s_waitcnt lgkmcnt(10)
  v_mfma_f32_16x16x32_bf16 v[48:51], v[84:87], v[120:123], v[48:51]
  ds_read_b64_tr_b16 v[112:113], v3 offset:7328
  v_mfma_f32_16x16x32_bf16 v[52:55], v[84:87], v[124:127], v[52:55]
  ds_read_b64_tr_b16 v[114:115], v3 offset:10912
  v_mfma_f32_16x16x32_bf16 v[56:59], v[88:91], v[120:123], v[56:59]
  ds_read_b64_tr_b16 v[116:117], v3 offset:7360
  v_mfma_f32_16x16x32_bf16 v[60:63], v[88:91], v[124:127], v[60:63]
  ds_read_b64_tr_b16 v[118:119], v3 offset:10944
  s_waitcnt vmcnt(6) lgkmcnt(8)
  v_mfma_f32_16x16x32_bf16 v[8:11], v[92:95], v[128:131], v[8:11]
  ds_read_b64_tr_b16 v[64:65], v3 offset:14336
  v_mfma_f32_16x16x32_bf16 v[12:15], v[92:95], v[132:135], v[12:15]
  ds_read_b64_tr_b16 v[66:67], v3 offset:17920
  v_mfma_f32_16x16x32_bf16 v[16:19], v[96:99], v[128:131], v[16:19]
  ds_read_b64_tr_b16 v[68:69], v3 offset:14368
  buffer_load_dwordx4 v[160:163], v2, s[32:35], s57 offen offset:1024 sc1
  v_mfma_f32_16x16x32_bf16 v[20:23], v[96:99], v[132:135], v[20:23]
  ds_read_b64_tr_b16 v[70:71], v3 offset:17952
  buffer_load_dwordx4 v[164:167], v2, s[32:35], s58 offen offset:1024 sc1
  v_mfma_f32_16x16x32_bf16 v[24:27], v[100:103], v[128:131], v[24:27]
  ds_read_b64_tr_b16 v[72:73], v3 offset:14400
  v_mfma_f32_16x16x32_bf16 v[28:31], v[100:103], v[132:135], v[28:31]
  ds_read_b64_tr_b16 v[74:75], v3 offset:17984
  s_waitcnt lgkmcnt(10)
  v_mfma_f32_16x16x32_bf16 v[32:35], v[104:107], v[128:131], v[32:35]
  ds_read_b64_tr_b16 v[76:77], v3 offset:14432
  v_mfma_f32_16x16x32_bf16 v[36:39], v[104:107], v[132:135], v[36:39]
  ds_read_b64_tr_b16 v[78:79], v3 offset:18016
  v_mfma_f32_16x16x32_bf16 v[40:43], v[108:111], v[128:131], v[40:43]
  ds_read_b64_tr_b16 v[80:81], v3 offset:14464
  v_mfma_f32_16x16x32_bf16 v[44:47], v[108:111], v[132:135], v[44:47]
  ds_read_b64_tr_b16 v[82:83], v3 offset:18048
  s_waitcnt lgkmcnt(10)
  v_mfma_f32_16x16x32_bf16 v[48:51], v[112:115], v[128:131], v[48:51]
  ds_read_b64_tr_b16 v[84:85], v3 offset:14496
  v_mfma_f32_16x16x32_bf16 v[52:55], v[112:115], v[132:135], v[52:55]
  ds_read_b64_tr_b16 v[86:87], v3 offset:18080
  v_mfma_f32_16x16x32_bf16 v[56:59], v[116:119], v[128:131], v[56:59]
  ds_read_b64_tr_b16 v[88:89], v3 offset:14528
  v_mfma_f32_16x16x32_bf16 v[60:63], v[116:119], v[132:135], v[60:63]
  ds_read_b64_tr_b16 v[90:91], v3 offset:18112
  s_waitcnt vmcnt(6) lgkmcnt(8)
  v_mfma_f32_16x16x32_bf16 v[8:11], v[64:67], v[136:139], v[8:11]
  ds_read_b64_tr_b16 v[92:93], v3 offset:21504
  v_mfma_f32_16x16x32_bf16 v[12:15], v[64:67], v[140:143], v[12:15]
  ds_read_b64_tr_b16 v[94:95], v3 offset:25088
  v_mfma_f32_16x16x32_bf16 v[16:19], v[68:71], v[136:139], v[16:19]
  ds_read_b64_tr_b16 v[96:97], v3 offset:21536
  buffer_load_dwordx4 v[168:171], v2, s[32:35], s57 offen offset:2048 sc1
  v_mfma_f32_16x16x32_bf16 v[20:23], v[68:71], v[140:143], v[20:23]
  ds_read_b64_tr_b16 v[98:99], v3 offset:25120
  buffer_load_dwordx4 v[172:175], v2, s[32:35], s58 offen offset:2048 sc1
  v_mfma_f32_16x16x32_bf16 v[24:27], v[72:75], v[136:139], v[24:27]
  ds_read_b64_tr_b16 v[100:101], v3 offset:21568
  v_mfma_f32_16x16x32_bf16 v[28:31], v[72:75], v[140:143], v[28:31]
  ds_read_b64_tr_b16 v[102:103], v3 offset:25152
  s_waitcnt lgkmcnt(10)
  v_mfma_f32_16x16x32_bf16 v[32:35], v[76:79], v[136:139], v[32:35]
  ds_read_b64_tr_b16 v[104:105], v3 offset:21600
  v_mfma_f32_16x16x32_bf16 v[36:39], v[76:79], v[140:143], v[36:39]
  ds_read_b64_tr_b16 v[106:107], v3 offset:25184
  v_mfma_f32_16x16x32_bf16 v[40:43], v[80:83], v[136:139], v[40:43]
  ds_read_b64_tr_b16 v[108:109], v3 offset:21632
  v_mfma_f32_16x16x32_bf16 v[44:47], v[80:83], v[140:143], v[44:47]
  ds_read_b64_tr_b16 v[110:111], v3 offset:25216
  s_waitcnt lgkmcnt(10)
  v_mfma_f32_16x16x32_bf16 v[48:51], v[84:87], v[136:139], v[48:51]
  ds_read_b64_tr_b16 v[112:113], v3 offset:21664
  v_mfma_f32_16x16x32_bf16 v[52:55], v[84:87], v[140:143], v[52:55]
  ds_read_b64_tr_b16 v[114:115], v3 offset:25248
  v_mfma_f32_16x16x32_bf16 v[56:59], v[88:91], v[136:139], v[56:59]
  ds_read_b64_tr_b16 v[116:117], v3 offset:21696
  v_mfma_f32_16x16x32_bf16 v[60:63], v[88:91], v[140:143], v[60:63]
  ds_read_b64_tr_b16 v[118:119], v3 offset:25280
  s_waitcnt vmcnt(6) lgkmcnt(8)
  v_mfma_f32_16x16x32_bf16 v[8:11], v[92:95], v[144:147], v[8:11]
  ds_read_b64_tr_b16 v[64:65], v3 offset:28672
  v_mfma_f32_16x16x32_bf16 v[12:15], v[92:95], v[148:151], v[12:15]
  ds_read_b64_tr_b16 v[66:67], v3 offset:32256
  v_mfma_f32_16x16x32_bf16 v[16:19], v[96:99], v[144:147], v[16:19]
  ds_read_b64_tr_b16 v[68:69], v3 offset:28704
  buffer_load_dwordx4 v[176:179], v2, s[32:35], s57 offen offset:3072 sc1
  v_mfma_f32_16x16x32_bf16 v[20:23], v[96:99], v[148:151], v[20:23]
  ds_read_b64_tr_b16 v[70:71], v3 offset:32288
  buffer_load_dwordx4 v[180:183], v2, s[32:35], s58 offen offset:3072 sc1
  s_add_u32 s57, s57, 4096
  s_add_u32 s58, s58, 4096
  v_mfma_f32_16x16x32_bf16 v[24:27], v[100:103], v[144:147], v[24:27]
  ds_read_b64_tr_b16 v[72:73], v3 offset:28736
  v_mfma_f32_16x16x32_bf16 v[28:31], v[100:103], v[148:151], v[28:31]
  ds_read_b64_tr_b16 v[74:75], v3 offset:32320
  s_waitcnt lgkmcnt(10)
  v_mfma_f32_16x16x32_bf16 v[32:35], v[104:107], v[144:147], v[32:35]
  ds_read_b64_tr_b16 v[76:77], v3 offset:28768
  v_mfma_f32_16x16x32_bf16 v[36:39], v[104:107], v[148:151], v[36:39]
  ds_read_b64_tr_b16 v[78:79], v3 offset:32352
  v_mfma_f32_16x16x32_bf16 v[40:43], v[108:111], v[144:147], v[40:43]
  ds_read_b64_tr_b16 v[80:81], v3 offset:28800
  v_mfma_f32_16x16x32_bf16 v[44:47], v[108:111], v[148:151], v[44:47]
  ds_read_b64_tr_b16 v[82:83], v3 offset:32384
  s_waitcnt lgkmcnt(10)
  v_mfma_f32_16x16x32_bf16 v[48:51], v[112:115], v[144:147], v[48:51]
  ds_read_b64_tr_b16 v[84:85], v3 offset:28832
  v_mfma_f32_16x16x32_bf16 v[52:55], v[112:115], v[148:151], v[52:55]
  ds_read_b64_tr_b16 v[86:87], v3 offset:32416
  v_mfma_f32_16x16x32_bf16 v[56:59], v[116:119], v[144:147], v[56:59]
  ds_read_b64_tr_b16 v[88:89], v3 offset:28864
  v_mfma_f32_16x16x32_bf16 v[60:63], v[116:119], v[148:151], v[60:63]
  ds_read_b64_tr_b16 v[90:91], v3 offset:32448
  s_waitcnt vmcnt(6) lgkmcnt(8)
  v_mfma_f32_16x16x32_bf16 v[8:11], v[64:67], v[152:155], v[8:11]
  ds_read_b64_tr_b16 v[92:93], v3 offset:35840
  v_mfma_f32_16x16x32_bf16 v[12:15], v[64:67], v[156:159], v[12:15]
  ds_read_b64_tr_b16 v[94:95], v3 offset:39424
  v_mfma_f32_16x16x32_bf16 v[16:19], v[68:71], v[152:155], v[16:19]
  ds_read_b64_tr_b16 v[96:97], v3 offset:35872
  buffer_load_dwordx4 v[184:187], v2, s[32:35], s57 offen offset:0 sc1
  v_mfma_f32_16x16x32_bf16 v[20:23], v[68:71], v[156:159], v[20:23]
  ds_read_b64_tr_b16 v[98:99], v3 offset:39456
  buffer_load_dwordx4 v[188:191], v2, s[32:35], s58 offen offset:0 sc1
  v_mfma_f32_16x16x32_bf16 v[24:27], v[72:75], v[152:155], v[24:27]
  ds_read_b64_tr_b16 v[100:101], v3 offset:35904
  v_mfma_f32_16x16x32_bf16 v[28:31], v[72:75], v[156:159], v[28:31]
  ds_read_b64_tr_b16 v[102:103], v3 offset:39488
  s_waitcnt lgkmcnt(10)
  v_mfma_f32_16x16x32_bf16 v[32:35], v[76:79], v[152:155], v[32:35]
  ds_read_b64_tr_b16 v[104:105], v3 offset:35936
  v_mfma_f32_16x16x32_bf16 v[36:39], v[76:79], v[156:159], v[36:39]
  ds_read_b64_tr_b16 v[106:107], v3 offset:39520
  v_mfma_f32_16x16x32_bf16 v[40:43], v[80:83], v[152:155], v[40:43]
  ds_read_b64_tr_b16 v[108:109], v3 offset:35968
  v_mfma_f32_16x16x32_bf16 v[44:47], v[80:83], v[156:159], v[44:47]
  ds_read_b64_tr_b16 v[110:111], v3 offset:39552
  s_waitcnt lgkmcnt(10)
  v_mfma_f32_16x16x32_bf16 v[48:51], v[84:87], v[152:155], v[48:51]
  ds_read_b64_tr_b16 v[112:113], v3 offset:36000
  v_mfma_f32_16x16x32_bf16 v[52:55], v[84:87], v[156:159], v[52:55]
  ds_read_b64_tr_b16 v[114:115], v3 offset:39584
  v_mfma_f32_16x16x32_bf16 v[56:59], v[88:91], v[152:155], v[56:59]
  ds_read_b64_tr_b16 v[116:117], v3 offset:36032
  v_mfma_f32_16x16x32_bf16 v[60:63], v[88:91], v[156:159], v[60:63]
  ds_read_b64_tr_b16 v[118:119], v3 offset:39616
  s_waitcnt vmcnt(6) lgkmcnt(8)
  v_mfma_f32_16x16x32_bf16 v[8:11], v[92:95], v[160:163], v[8:11]
  ds_read_b64_tr_b16 v[64:65], v3 offset:43008
  v_mfma_f32_16x16x32_bf16 v[12:15], v[92:95], v[164:167], v[12:15]
  ds_read_b64_tr_b16 v[66:67], v3 offset:46592
  v_mfma_f32_16x16x32_bf16 v[16:19], v[96:99], v[160:163], v[16:19]
  ds_read_b64_tr_b16 v[68:69], v3 offset:43040
  buffer_load_dwordx4 v[192:195], v2, s[32:35], s57 offen offset:1024 sc1
  v_mfma_f32_16x16x32_bf16 v[20:23], v[96:99], v[164:167], v[20:23]
  ds_read_b64_tr_b16 v[70:71], v3 offset:46624
  buffer_load_dwordx4 v[196:199], v2, s[32:35], s58 offen offset:1024 sc1
  v_mfma_f32_16x16x32_bf16 v[24:27], v[100:103], v[160:163], v[24:27]
  ds_read_b64_tr_b16 v[72:73], v3 offset:43072
  v_mfma_f32_16x16x32_bf16 v[28:31], v[100:103], v[164:167], v[28:31]
  ds_read_b64_tr_b16 v[74:75], v3 offset:46656
  s_waitcnt lgkmcnt(10)
  v_mfma_f32_16x16x32_bf16 v[32:35], v[104:107], v[160:163], v[32:35]
  ds_read_b64_tr_b16 v[76:77], v3 offset:43104
  v_mfma_f32_16x16x32_bf16 v[36:39], v[104:107], v[164:167], v[36:39]
  ds_read_b64_tr_b16 v[78:79], v3 offset:46688
  v_mfma_f32_16x16x32_bf16 v[40:43], v[108:111], v[160:163], v[40:43]
  ds_read_b64_tr_b16 v[80:81], v3 offset:43136
  v_mfma_f32_16x16x32_bf16 v[44:47], v[108:111], v[164:167], v[44:47]
  ds_read_b64_tr_b16 v[82:83], v3 offset:46720
  s_waitcnt lgkmcnt(10)
  v_mfma_f32_16x16x32_bf16 v[48:51], v[112:115], v[160:163], v[48:51]
  ds_read_b64_tr_b16 v[84:85], v3 offset:43168
  v_mfma_f32_16x16x32_bf16 v[52:55], v[112:115], v[164:167], v[52:55]
  ds_read_b64_tr_b16 v[86:87], v3 offset:46752
  v_mfma_f32_16x16x32_bf16 v[56:59], v[116:119], v[160:163], v[56:59]
  ds_read_b64_tr_b16 v[88:89], v3 offset:43200
  v_mfma_f32_16x16x32_bf16 v[60:63], v[116:119], v[164:167], v[60:63]
  ds_read_b64_tr_b16 v[90:91], v3 offset:46784
  s_waitcnt vmcnt(6) lgkmcnt(8)
  v_mfma_f32_16x16x32_bf16 v[8:11], v[64:67], v[168:171], v[8:11]
  ds_read_b64_tr_b16 v[92:93], v3 offset:50176
  v_mfma_f32_16x16x32_bf16 v[12:15], v[64:67], v[172:175], v[12:15]
  ds_read_b64_tr_b16 v[94:95], v3 offset:53760
  v_mfma_f32_16x16x32_bf16 v[16:19], v[68:71], v[168:171], v[16:19]
  ds_read_b64_tr_b16 v[96:97], v3 offset:50208
  buffer_load_dwordx4 v[200:203], v2, s[32:35], s57 offen offset:2048 sc1
  v_mfma_f32_16x16x32_bf16 v[20:23], v[68:71], v[172:175], v[20:23]
  ds_read_b64_tr_b16 v[98:99], v3 offset:53792
  buffer_load_dwordx4 v[204:207], v2, s[32:35], s58 offen offset:2048 sc1
  v_mfma_f32_16x16x32_bf16 v[24:27], v[72:75], v[168:171], v[24:27]
  ds_read_b64_tr_b16 v[100:101], v3 offset:50240
  v_mfma_f32_16x16x32_bf16 v[28:31], v[72:75], v[172:175], v[28:31]
  ds_read_b64_tr_b16 v[102:103], v3 offset:53824
  s_waitcnt lgkmcnt(10)
  v_mfma_f32_16x16x32_bf16 v[32:35], v[76:79], v[168:171], v[32:35]
  ds_read_b64_tr_b16 v[104:105], v3 offset:50272
  v_mfma_f32_16x16x32_bf16 v[36:39], v[76:79], v[172:175], v[36:39]
  ds_read_b64_tr_b16 v[106:107], v3 offset:53856
  v_mfma_f32_16x16x32_bf16 v[40:43], v[80:83], v[168:171], v[40:43]
  ds_read_b64_tr_b16 v[108:109], v3 offset:50304
  v_mfma_f32_16x16x32_bf16 v[44:47], v[80:83], v[172:175], v[44:47]
  ds_read_b64_tr_b16 v[110:111], v3 offset:53888
  s_waitcnt lgkmcnt(10)
  v_mfma_f32_16x16x32_bf16 v[48:51], v[84:87], v[168:171], v[48:51]
  ds_read_b64_tr_b16 v[112:113], v3 offset:50336
  v_mfma_f32_16x16x32_bf16 v[52:55], v[84:87], v[172:175], v[52:55]
  ds_read_b64_tr_b16 v[114:115], v3 offset:53920
  v_mfma_f32_16x16x32_bf16 v[56:59], v[88:91], v[168:171], v[56:59]
  ds_read_b64_tr_b16 v[116:117], v3 offset:50368
  v_mfma_f32_16x16x32_bf16 v[60:63], v[88:91], v[172:175], v[60:63]
  ds_read_b64_tr_b16 v[118:119], v3 offset:53952
  s_waitcnt vmcnt(6) lgkmcnt(8)
  v_mfma_f32_16x16x32_bf16 v[8:11], v[92:95], v[176:179], v[8:11]
  ds_read_b64_tr_b16 v[64:65], v4 offset:0
  v_mfma_f32_16x16x32_bf16 v[12:15], v[92:95], v[180:183], v[12:15]
  ds_read_b64_tr_b16 v[66:67], v4 offset:3584
  v_mfma_f32_16x16x32_bf16 v[16:19], v[96:99], v[176:179], v[16:19]
  ds_read_b64_tr_b16 v[68:69], v4 offset:32
  buffer_load_dwordx4 v[208:211], v2, s[32:35], s57 offen offset:3072 sc1
  v_mfma_f32_16x16x32_bf16 v[20:23], v[96:99], v[180:183], v[20:23]
  ds_read_b64_tr_b16 v[70:71], v4 offset:3616
  buffer_load_dwordx4 v[212:215], v2, s[32:35], s58 offen offset:3072 sc1
  s_add_u32 s57, s57, 4096
  s_add_u32 s58, s58, 4096
  v_mfma_f32_16x16x32_bf16 v[24:27], v[100:103], v[176:179], v[24:27]
  ds_read_b64_tr_b16 v[72:73], v4 offset:64
  v_mfma_f32_16x16x32_bf16 v[28:31], v[100:103], v[180:183], v[28:31]
  ds_read_b64_tr_b16 v[74:75], v4 offset:3648
  s_waitcnt lgkmcnt(10)
  v_mfma_f32_16x16x32_bf16 v[32:35], v[104:107], v[176:179], v[32:35]
  ds_read_b64_tr_b16 v[76:77], v4 offset:96
  v_mfma_f32_16x16x32_bf16 v[36:39], v[104:107], v[180:183], v[36:39]
  ds_read_b64_tr_b16 v[78:79], v4 offset:3680
  v_mfma_f32_16x16x32_bf16 v[40:43], v[108:111], v[176:179], v[40:43]
  ds_read_b64_tr_b16 v[80:81], v4 offset:128
  v_mfma_f32_16x16x32_bf16 v[44:47], v[108:111], v[180:183], v[44:47]
  ds_read_b64_tr_b16 v[82:83], v4 offset:3712
  s_waitcnt lgkmcnt(10)
  v_mfma_f32_16x16x32_bf16 v[48:51], v[112:115], v[176:179], v[48:51]
  ds_read_b64_tr_b16 v[84:85], v4 offset:160
  v_mfma_f32_16x16x32_bf16 v[52:55], v[112:115], v[180:183], v[52:55]
  ds_read_b64_tr_b16 v[86:87], v4 offset:3744
  v_mfma_f32_16x16x32_bf16 v[56:59], v[116:119], v[176:179], v[56:59]
  ds_read_b64_tr_b16 v[88:89], v4 offset:192
  v_mfma_f32_16x16x32_bf16 v[60:63], v[116:119], v[180:183], v[60:63]
  ds_read_b64_tr_b16 v[90:91], v4 offset:3776
  s_waitcnt vmcnt(6) lgkmcnt(8)
  v_mfma_f32_16x16x32_bf16 v[8:11], v[64:67], v[184:187], v[8:11]
  ds_read_b64_tr_b16 v[92:93], v4 offset:7168
  v_mfma_f32_16x16x32_bf16 v[12:15], v[64:67], v[188:191], v[12:15]
  ds_read_b64_tr_b16 v[94:95], v4 offset:10752
  v_mfma_f32_16x16x32_bf16 v[16:19], v[68:71], v[184:187], v[16:19]
  ds_read_b64_tr_b16 v[96:97], v4 offset:7200
  buffer_load_dwordx4 v[216:219], v2, s[32:35], s57 offen offset:0 sc1
  v_mfma_f32_16x16x32_bf16 v[20:23], v[68:71], v[188:191], v[20:23]
  ds_read_b64_tr_b16 v[98:99], v4 offset:10784
  buffer_load_dwordx4 v[220:223], v2, s[32:35], s58 offen offset:0 sc1
  v_mfma_f32_16x16x32_bf16 v[24:27], v[72:75], v[184:187], v[24:27]
  ds_read_b64_tr_b16 v[100:101], v4 offset:7232
  v_mfma_f32_16x16x32_bf16 v[28:31], v[72:75], v[188:191], v[28:31]
  ds_read_b64_tr_b16 v[102:103], v4 offset:10816
  s_waitcnt lgkmcnt(10)
  v_mfma_f32_16x16x32_bf16 v[32:35], v[76:79], v[184:187], v[32:35]
  ds_read_b64_tr_b16 v[104:105], v4 offset:7264
  v_mfma_f32_16x16x32_bf16 v[36:39], v[76:79], v[188:191], v[36:39]
  ds_read_b64_tr_b16 v[106:107], v4 offset:10848
  v_mfma_f32_16x16x32_bf16 v[40:43], v[80:83], v[184:187], v[40:43]
  ds_read_b64_tr_b16 v[108:109], v4 offset:7296
  v_mfma_f32_16x16x32_bf16 v[44:47], v[80:83], v[188:191], v[44:47]
  ds_read_b64_tr_b16 v[110:111], v4 offset:10880
  s_waitcnt lgkmcnt(10)
  v_mfma_f32_16x16x32_bf16 v[48:51], v[84:87], v[184:187], v[48:51]
  ds_read_b64_tr_b16 v[112:113], v4 offset:7328
  v_mfma_f32_16x16x32_bf16 v[52:55], v[84:87], v[188:191], v[52:55]
  ds_read_b64_tr_b16 v[114:115], v4 offset:10912
  v_mfma_f32_16x16x32_bf16 v[56:59], v[88:91], v[184:187], v[56:59]
  ds_read_b64_tr_b16 v[116:117], v4 offset:7360
  v_mfma_f32_16x16x32_bf16 v[60:63], v[88:91], v[188:191], v[60:63]
  ds_read_b64_tr_b16 v[118:119], v4 offset:10944
  s_waitcnt vmcnt(6) lgkmcnt(8)
  v_mfma_f32_16x16x32_bf16 v[8:11], v[92:95], v[192:195], v[8:11]
  ds_read_b64_tr_b16 v[64:65], v4 offset:14336
  v_mfma_f32_16x16x32_bf16 v[12:15], v[92:95], v[196:199], v[12:15]
  ds_read_b64_tr_b16 v[66:67], v4 offset:17920
  v_mfma_f32_16x16x32_bf16 v[16:19], v[96:99], v[192:195], v[16:19]
  ds_read_b64_tr_b16 v[68:69], v4 offset:14368
  buffer_load_dwordx4 v[224:227], v2, s[32:35], s57 offen offset:1024 sc1
  v_mfma_f32_16x16x32_bf16 v[20:23], v[96:99], v[196:199], v[20:23]
  ds_read_b64_tr_b16 v[70:71], v4 offset:17952
  buffer_load_dwordx4 v[228:231], v2, s[32:35], s58 offen offset:1024 sc1
  v_mfma_f32_16x16x32_bf16 v[24:27], v[100:103], v[192:195], v[24:27]
  ds_read_b64_tr_b16 v[72:73], v4 offset:14400
  v_mfma_f32_16x16x32_bf16 v[28:31], v[100:103], v[196:199], v[28:31]
  ds_read_b64_tr_b16 v[74:75], v4 offset:17984
  s_waitcnt lgkmcnt(10)
  v_mfma_f32_16x16x32_bf16 v[32:35], v[104:107], v[192:195], v[32:35]
  ds_read_b64_tr_b16 v[76:77], v4 offset:14432
  v_mfma_f32_16x16x32_bf16 v[36:39], v[104:107], v[196:199], v[36:39]
  ds_read_b64_tr_b16 v[78:79], v4 offset:18016
  v_mfma_f32_16x16x32_bf16 v[40:43], v[108:111], v[192:195], v[40:43]
  ds_read_b64_tr_b16 v[80:81], v4 offset:14464
  v_mfma_f32_16x16x32_bf16 v[44:47], v[108:111], v[196:199], v[44:47]
  ds_read_b64_tr_b16 v[82:83], v4 offset:18048
  s_waitcnt lgkmcnt(10)
  v_mfma_f32_16x16x32_bf16 v[48:51], v[112:115], v[192:195], v[48:51]
  ds_read_b64_tr_b16 v[84:85], v4 offset:14496
  v_mfma_f32_16x16x32_bf16 v[52:55], v[112:115], v[196:199], v[52:55]
  ds_read_b64_tr_b16 v[86:87], v4 offset:18080
  v_mfma_f32_16x16x32_bf16 v[56:59], v[116:119], v[192:195], v[56:59]
  ds_read_b64_tr_b16 v[88:89], v4 offset:14528
  v_mfma_f32_16x16x32_bf16 v[60:63], v[116:119], v[196:199], v[60:63]
  ds_read_b64_tr_b16 v[90:91], v4 offset:18112
  s_waitcnt vmcnt(6) lgkmcnt(8)
  v_mfma_f32_16x16x32_bf16 v[8:11], v[64:67], v[200:203], v[8:11]
  ds_read_b64_tr_b16 v[92:93], v4 offset:21504
  v_mfma_f32_16x16x32_bf16 v[12:15], v[64:67], v[204:207], v[12:15]
  ds_read_b64_tr_b16 v[94:95], v4 offset:25088
  v_mfma_f32_16x16x32_bf16 v[16:19], v[68:71], v[200:203], v[16:19]
  ds_read_b64_tr_b16 v[96:97], v4 offset:21536
  buffer_load_dwordx4 v[232:235], v2, s[32:35], s57 offen offset:2048 sc1
  v_mfma_f32_16x16x32_bf16 v[20:23], v[68:71], v[204:207], v[20:23]
  ds_read_b64_tr_b16 v[98:99], v4 offset:25120
  buffer_load_dwordx4 v[236:239], v2, s[32:35], s58 offen offset:2048 sc1
  v_mfma_f32_16x16x32_bf16 v[24:27], v[72:75], v[200:203], v[24:27]
  ds_read_b64_tr_b16 v[100:101], v4 offset:21568
  v_mfma_f32_16x16x32_bf16 v[28:31], v[72:75], v[204:207], v[28:31]
  ds_read_b64_tr_b16 v[102:103], v4 offset:25152
  s_waitcnt lgkmcnt(10)
  v_mfma_f32_16x16x32_bf16 v[32:35], v[76:79], v[200:203], v[32:35]
  ds_read_b64_tr_b16 v[104:105], v4 offset:21600
  v_mfma_f32_16x16x32_bf16 v[36:39], v[76:79], v[204:207], v[36:39]
  ds_read_b64_tr_b16 v[106:107], v4 offset:25184
  v_mfma_f32_16x16x32_bf16 v[40:43], v[80:83], v[200:203], v[40:43]
  ds_read_b64_tr_b16 v[108:109], v4 offset:21632
  v_mfma_f32_16x16x32_bf16 v[44:47], v[80:83], v[204:207], v[44:47]
  ds_read_b64_tr_b16 v[110:111], v4 offset:25216
  s_waitcnt lgkmcnt(10)
  v_mfma_f32_16x16x32_bf16 v[48:51], v[84:87], v[200:203], v[48:51]
  ds_read_b64_tr_b16 v[112:113], v4 offset:21664
  v_mfma_f32_16x16x32_bf16 v[52:55], v[84:87], v[204:207], v[52:55]
  ds_read_b64_tr_b16 v[114:115], v4 offset:25248
  v_mfma_f32_16x16x32_bf16 v[56:59], v[88:91], v[200:203], v[56:59]
  ds_read_b64_tr_b16 v[116:117], v4 offset:21696
  v_mfma_f32_16x16x32_bf16 v[60:63], v[88:91], v[204:207], v[60:63]
  ds_read_b64_tr_b16 v[118:119], v4 offset:25280
  s_waitcnt vmcnt(6) lgkmcnt(8)
  v_mfma_f32_16x16x32_bf16 v[8:11], v[92:95], v[208:211], v[8:11]
  ds_read_b64_tr_b16 v[64:65], v4 offset:28672
  v_mfma_f32_16x16x32_bf16 v[12:15], v[92:95], v[212:215], v[12:15]
  ds_read_b64_tr_b16 v[66:67], v4 offset:32256
  v_mfma_f32_16x16x32_bf16 v[16:19], v[96:99], v[208:211], v[16:19]
  ds_read_b64_tr_b16 v[68:69], v4 offset:28704
  buffer_load_dwordx4 v[240:243], v2, s[32:35], s57 offen offset:3072 sc1
  v_mfma_f32_16x16x32_bf16 v[20:23], v[96:99], v[212:215], v[20:23]
  ds_read_b64_tr_b16 v[70:71], v4 offset:32288
  buffer_load_dwordx4 v[244:247], v2, s[32:35], s58 offen offset:3072 sc1
  s_add_u32 s57, s57, 4096
  s_add_u32 s58, s58, 4096
  v_mfma_f32_16x16x32_bf16 v[24:27], v[100:103], v[208:211], v[24:27]
  ds_read_b64_tr_b16 v[72:73], v4 offset:28736
  v_mfma_f32_16x16x32_bf16 v[28:31], v[100:103], v[212:215], v[28:31]
  ds_read_b64_tr_b16 v[74:75], v4 offset:32320
  s_waitcnt lgkmcnt(10)
  v_mfma_f32_16x16x32_bf16 v[32:35], v[104:107], v[208:211], v[32:35]
  ds_read_b64_tr_b16 v[76:77], v4 offset:28768
  v_mfma_f32_16x16x32_bf16 v[36:39], v[104:107], v[212:215], v[36:39]
  ds_read_b64_tr_b16 v[78:79], v4 offset:32352
  v_mfma_f32_16x16x32_bf16 v[40:43], v[108:111], v[208:211], v[40:43]
  ds_read_b64_tr_b16 v[80:81], v4 offset:28800
  v_mfma_f32_16x16x32_bf16 v[44:47], v[108:111], v[212:215], v[44:47]
  ds_read_b64_tr_b16 v[82:83], v4 offset:32384
  s_waitcnt lgkmcnt(10)
  v_mfma_f32_16x16x32_bf16 v[48:51], v[112:115], v[208:211], v[48:51]
  ds_read_b64_tr_b16 v[84:85], v4 offset:28832
  v_mfma_f32_16x16x32_bf16 v[52:55], v[112:115], v[212:215], v[52:55]
  ds_read_b64_tr_b16 v[86:87], v4 offset:32416
  v_mfma_f32_16x16x32_bf16 v[56:59], v[116:119], v[208:211], v[56:59]
  ds_read_b64_tr_b16 v[88:89], v4 offset:28864
  v_mfma_f32_16x16x32_bf16 v[60:63], v[116:119], v[212:215], v[60:63]
  ds_read_b64_tr_b16 v[90:91], v4 offset:32448
  s_waitcnt vmcnt(6) lgkmcnt(8)
  v_mfma_f32_16x16x32_bf16 v[8:11], v[64:67], v[216:219], v[8:11]
  ds_read_b64_tr_b16 v[92:93], v4 offset:35840
  v_mfma_f32_16x16x32_bf16 v[12:15], v[64:67], v[220:223], v[12:15]
  ds_read_b64_tr_b16 v[94:95], v4 offset:39424
  v_mfma_f32_16x16x32_bf16 v[16:19], v[68:71], v[216:219], v[16:19]
  ds_read_b64_tr_b16 v[96:97], v4 offset:35872
  v_mfma_f32_16x16x32_bf16 v[20:23], v[68:71], v[220:223], v[20:23]
  ds_read_b64_tr_b16 v[98:99], v4 offset:39456
  v_mfma_f32_16x16x32_bf16 v[24:27], v[72:75], v[216:219], v[24:27]
  ds_read_b64_tr_b16 v[100:101], v4 offset:35904
  v_mfma_f32_16x16x32_bf16 v[28:31], v[72:75], v[220:223], v[28:31]
  ds_read_b64_tr_b16 v[102:103], v4 offset:39488
  s_waitcnt lgkmcnt(10)
  v_mfma_f32_16x16x32_bf16 v[32:35], v[76:79], v[216:219], v[32:35]
  ds_read_b64_tr_b16 v[104:105], v4 offset:35936
  v_mfma_f32_16x16x32_bf16 v[36:39], v[76:79], v[220:223], v[36:39]
  ds_read_b64_tr_b16 v[106:107], v4 offset:39520
  v_mfma_f32_16x16x32_bf16 v[40:43], v[80:83], v[216:219], v[40:43]
  ds_read_b64_tr_b16 v[108:109], v4 offset:35968
  v_mfma_f32_16x16x32_bf16 v[44:47], v[80:83], v[220:223], v[44:47]
  ds_read_b64_tr_b16 v[110:111], v4 offset:39552
  s_waitcnt lgkmcnt(10)
  v_mfma_f32_16x16x32_bf16 v[48:51], v[84:87], v[216:219], v[48:51]
  ds_read_b64_tr_b16 v[112:113], v4 offset:36000
  v_mfma_f32_16x16x32_bf16 v[52:55], v[84:87], v[220:223], v[52:55]
  ds_read_b64_tr_b16 v[114:115], v4 offset:39584
  v_mfma_f32_16x16x32_bf16 v[56:59], v[88:91], v[216:219], v[56:59]
  ds_read_b64_tr_b16 v[116:117], v4 offset:36032
  v_mfma_f32_16x16x32_bf16 v[60:63], v[88:91], v[220:223], v[60:63]
  ds_read_b64_tr_b16 v[118:119], v4 offset:39616
  s_waitcnt vmcnt(4) lgkmcnt(8)
  v_mfma_f32_16x16x32_bf16 v[8:11], v[92:95], v[224:227], v[8:11]
  ds_read_b64_tr_b16 v[64:65], v4 offset:43008
  v_mfma_f32_16x16x32_bf16 v[12:15], v[92:95], v[228:231], v[12:15]
  ds_read_b64_tr_b16 v[66:67], v4 offset:46592
  v_mfma_f32_16x16x32_bf16 v[16:19], v[96:99], v[224:227], v[16:19]
  ds_read_b64_tr_b16 v[68:69], v4 offset:43040
  v_mfma_f32_16x16x32_bf16 v[20:23], v[96:99], v[228:231], v[20:23]
  ds_read_b64_tr_b16 v[70:71], v4 offset:46624
  v_mfma_f32_16x16x32_bf16 v[24:27], v[100:103], v[224:227], v[24:27]
  ds_read_b64_tr_b16 v[72:73], v4 offset:43072
  v_mfma_f32_16x16x32_bf16 v[28:31], v[100:103], v[228:231], v[28:31]
  ds_read_b64_tr_b16 v[74:75], v4 offset:46656
  s_waitcnt lgkmcnt(10)
  v_mfma_f32_16x16x32_bf16 v[32:35], v[104:107], v[224:227], v[32:35]
  ds_read_b64_tr_b16 v[76:77], v4 offset:43104
  v_mfma_f32_16x16x32_bf16 v[36:39], v[104:107], v[228:231], v[36:39]
  ds_read_b64_tr_b16 v[78:79], v4 offset:46688
  v_mfma_f32_16x16x32_bf16 v[40:43], v[108:111], v[224:227], v[40:43]
  ds_read_b64_tr_b16 v[80:81], v4 offset:43136
  v_mfma_f32_16x16x32_bf16 v[44:47], v[108:111], v[228:231], v[44:47]
  ds_read_b64_tr_b16 v[82:83], v4 offset:46720
  s_waitcnt lgkmcnt(10)
  v_mfma_f32_16x16x32_bf16 v[48:51], v[112:115], v[224:227], v[48:51]
  ds_read_b64_tr_b16 v[84:85], v4 offset:43168
  v_mfma_f32_16x16x32_bf16 v[52:55], v[112:115], v[228:231], v[52:55]
  ds_read_b64_tr_b16 v[86:87], v4 offset:46752
  v_mfma_f32_16x16x32_bf16 v[56:59], v[116:119], v[224:227], v[56:59]
  ds_read_b64_tr_b16 v[88:89], v4 offset:43200
  v_mfma_f32_16x16x32_bf16 v[60:63], v[116:119], v[228:231], v[60:63]
  ds_read_b64_tr_b16 v[90:91], v4 offset:46784
  s_waitcnt vmcnt(2) lgkmcnt(8)
  v_mfma_f32_16x16x32_bf16 v[8:11], v[64:67], v[232:235], v[8:11]
  ds_read_b64_tr_b16 v[92:93], v4 offset:50176
  v_mfma_f32_16x16x32_bf16 v[12:15], v[64:67], v[236:239], v[12:15]
  ds_read_b64_tr_b16 v[94:95], v4 offset:53760
  v_mfma_f32_16x16x32_bf16 v[16:19], v[68:71], v[232:235], v[16:19]
  ds_read_b64_tr_b16 v[96:97], v4 offset:50208
  v_mfma_f32_16x16x32_bf16 v[20:23], v[68:71], v[236:239], v[20:23]
  ds_read_b64_tr_b16 v[98:99], v4 offset:53792
  v_mfma_f32_16x16x32_bf16 v[24:27], v[72:75], v[232:235], v[24:27]
  ds_read_b64_tr_b16 v[100:101], v4 offset:50240
  v_mfma_f32_16x16x32_bf16 v[28:31], v[72:75], v[236:239], v[28:31]
  ds_read_b64_tr_b16 v[102:103], v4 offset:53824
  s_waitcnt lgkmcnt(10)
  v_mfma_f32_16x16x32_bf16 v[32:35], v[76:79], v[232:235], v[32:35]
  ds_read_b64_tr_b16 v[104:105], v4 offset:50272
  v_mfma_f32_16x16x32_bf16 v[36:39], v[76:79], v[236:239], v[36:39]
  ds_read_b64_tr_b16 v[106:107], v4 offset:53856
  v_mfma_f32_16x16x32_bf16 v[40:43], v[80:83], v[232:235], v[40:43]
  ds_read_b64_tr_b16 v[108:109], v4 offset:50304
  v_mfma_f32_16x16x32_bf16 v[44:47], v[80:83], v[236:239], v[44:47]
  ds_read_b64_tr_b16 v[110:111], v4 offset:53888
  s_waitcnt lgkmcnt(10)
  v_mfma_f32_16x16x32_bf16 v[48:51], v[84:87], v[232:235], v[48:51]
  ds_read_b64_tr_b16 v[112:113], v4 offset:50336
  v_mfma_f32_16x16x32_bf16 v[52:55], v[84:87], v[236:239], v[52:55]
  ds_read_b64_tr_b16 v[114:115], v4 offset:53920
  v_mfma_f32_16x16x32_bf16 v[56:59], v[88:91], v[232:235], v[56:59]
  ds_read_b64_tr_b16 v[116:117], v4 offset:50368
  v_mfma_f32_16x16x32_bf16 v[60:63], v[88:91], v[236:239], v[60:63]
  ds_read_b64_tr_b16 v[118:119], v4 offset:53952
  s_waitcnt vmcnt(0) lgkmcnt(8)
  v_mfma_f32_16x16x32_bf16 v[8:11], v[92:95], v[240:243], v[8:11]
  v_mfma_f32_16x16x32_bf16 v[12:15], v[92:95], v[244:247], v[12:15]
  v_mfma_f32_16x16x32_bf16 v[16:19], v[96:99], v[240:243], v[16:19]
  v_mfma_f32_16x16x32_bf16 v[20:23], v[96:99], v[244:247], v[20:23]
  v_mfma_f32_16x16x32_bf16 v[24:27], v[100:103], v[240:243], v[24:27]
  v_mfma_f32_16x16x32_bf16 v[28:31], v[100:103], v[244:247], v[28:31]
  s_waitcnt lgkmcnt(4)
  v_mfma_f32_16x16x32_bf16 v[32:35], v[104:107], v[240:243], v[32:35]
  v_mfma_f32_16x16x32_bf16 v[36:39], v[104:107], v[244:247], v[36:39]
  v_mfma_f32_16x16x32_bf16 v[40:43], v[108:111], v[240:243], v[40:43]
  v_mfma_f32_16x16x32_bf16 v[44:47], v[108:111], v[244:247], v[44:47]
  s_waitcnt lgkmcnt(0)
  v_mfma_f32_16x16x32_bf16 v[48:51], v[112:115], v[240:243], v[48:51]
  v_mfma_f32_16x16x32_bf16 v[52:55], v[112:115], v[244:247], v[52:55]
  v_mfma_f32_16x16x32_bf16 v[56:59], v[116:119], v[240:243], v[56:59]
  v_mfma_f32_16x16x32_bf16 v[60:63], v[116:119], v[244:247], v[60:63]
  v_mov_b32 v64, 0xbdd2d3e8
  v_mov_b32 v66, 0xc0135761
  v_mov_b32 v68, 1.0
  s_lshl_b32 s57, s4, 4
  s_lshl_b32 s58, s93, 3
  s_add_u32 s57, s57, s58
  s_lshl_b32 s58, s6, 1
  s_add_u32 s57, s57, s58
  s_mul_i32 s57, s57, 57344
  s_add_u32 s57, s57, s72
  s_lshr_b32 s58, s94, 1
  s_mul_i32 s58, s58, 7168
  s_add_u32 s57, s57, s58
  s_and_b32 s59, s94, 1
  s_mul_i32 s58, s59, 3072
  s_add_u32 s58, s57, s58
  s_lshl_b32 s59, s59, 3
  s_add_u32 s59, s57, s59
  s_add_u32 s59, s59, 6144
  s_add_u32 s60, s58, 57344
  s_add_u32 s61, s59, 57344
  v_pk_mul_f32 v[72:73], v[8:9], v[8:9]
  v_pk_mul_f32 v[74:75], v[10:11], v[10:11]
  v_pk_fma_f32 v[72:73], v[72:73], v[64:65], v[66:67] op_sel_hi:[1,0,0]
  v_pk_fma_f32 v[74:75], v[74:75], v[64:65], v[66:67] op_sel_hi:[1,0,0]
  v_pk_mul_f32 v[72:73], v[72:73], v[8:9]
  v_pk_mul_f32 v[74:75], v[74:75], v[10:11]
  v_exp_f32 v72, v72
  v_exp_f32 v73, v73
  v_exp_f32 v74, v74
  v_exp_f32 v75, v75
  v_pk_add_f32 v[72:73], v[72:73], v[68:69] op_sel_hi:[1,0]
  v_pk_add_f32 v[74:75], v[74:75], v[68:69] op_sel_hi:[1,0]
  v_rcp_f32 v72, v72
  v_rcp_f32 v73, v73
  v_rcp_f32 v74, v74
  v_rcp_f32 v75, v75
  v_pk_mul_f32 v[8:9], v[8:9], v[72:73]
  v_pk_mul_f32 v[10:11], v[10:11], v[74:75]
  v_cvt_pk_bf16_f32 v80, v8, v9
  v_cvt_pk_bf16_f32 v81, v10, v11
  v_pk_mul_f32 v[76:77], v[16:17], v[16:17]
  v_pk_mul_f32 v[78:79], v[18:19], v[18:19]
  v_pk_fma_f32 v[76:77], v[76:77], v[64:65], v[66:67] op_sel_hi:[1,0,0]
  v_pk_fma_f32 v[78:79], v[78:79], v[64:65], v[66:67] op_sel_hi:[1,0,0]
  v_pk_mul_f32 v[76:77], v[76:77], v[16:17]
  v_pk_mul_f32 v[78:79], v[78:79], v[18:19]
  v_exp_f32 v76, v76
  v_exp_f32 v77, v77
  v_exp_f32 v78, v78
  v_exp_f32 v79, v79
  v_pk_add_f32 v[76:77], v[76:77], v[68:69] op_sel_hi:[1,0]
  v_pk_add_f32 v[78:79], v[78:79], v[68:69] op_sel_hi:[1,0]
  v_rcp_f32 v76, v76
  v_rcp_f32 v77, v77
  v_rcp_f32 v78, v78
  v_rcp_f32 v79, v79
  v_pk_mul_f32 v[16:17], v[16:17], v[76:77]
  v_pk_mul_f32 v[18:19], v[18:19], v[78:79]
  v_cvt_pk_bf16_f32 v82, v16, v17
  v_cvt_pk_bf16_f32 v83, v18, v19
  buffer_store_dwordx4 v[80:83], v2, s[32:35], s58 offen offset:0
  v_pk_mul_f32 v[72:73], v[24:25], v[24:25]
  v_pk_mul_f32 v[74:75], v[26:27], v[26:27]
  v_pk_fma_f32 v[72:73], v[72:73], v[64:65], v[66:67] op_sel_hi:[1,0,0]
  v_pk_fma_f32 v[74:75], v[74:75], v[64:65], v[66:67] op_sel_hi:[1,0,0]
  v_pk_mul_f32 v[72:73], v[72:73], v[24:25]
  v_pk_mul_f32 v[74:75], v[74:75], v[26:27]
  v_exp_f32 v72, v72
  v_exp_f32 v73, v73
  v_exp_f32 v74, v74
  v_exp_f32 v75, v75
  v_pk_add_f32 v[72:73], v[72:73], v[68:69] op_sel_hi:[1,0]
  v_pk_add_f32 v[74:75], v[74:75], v[68:69] op_sel_hi:[1,0]
  v_rcp_f32 v72, v72
  v_rcp_f32 v73, v73
  v_rcp_f32 v74, v74
  v_rcp_f32 v75, v75
  v_pk_mul_f32 v[24:25], v[24:25], v[72:73]
  v_pk_mul_f32 v[26:27], v[26:27], v[74:75]
  v_cvt_pk_bf16_f32 v84, v24, v25
  v_cvt_pk_bf16_f32 v85, v26, v27
  v_pk_mul_f32 v[76:77], v[32:33], v[32:33]
  v_pk_mul_f32 v[78:79], v[34:35], v[34:35]
  v_pk_fma_f32 v[76:77], v[76:77], v[64:65], v[66:67] op_sel_hi:[1,0,0]
  v_pk_fma_f32 v[78:79], v[78:79], v[64:65], v[66:67] op_sel_hi:[1,0,0]
  v_pk_mul_f32 v[76:77], v[76:77], v[32:33]
  v_pk_mul_f32 v[78:79], v[78:79], v[34:35]
  v_exp_f32 v76, v76
  v_exp_f32 v77, v77
  v_exp_f32 v78, v78
  v_exp_f32 v79, v79
  v_pk_add_f32 v[76:77], v[76:77], v[68:69] op_sel_hi:[1,0]
  v_pk_add_f32 v[78:79], v[78:79], v[68:69] op_sel_hi:[1,0]
  v_rcp_f32 v76, v76
  v_rcp_f32 v77, v77
  v_rcp_f32 v78, v78
  v_rcp_f32 v79, v79
  v_pk_mul_f32 v[32:33], v[32:33], v[76:77]
  v_pk_mul_f32 v[34:35], v[34:35], v[78:79]
  v_cvt_pk_bf16_f32 v86, v32, v33
  v_cvt_pk_bf16_f32 v87, v34, v35
  buffer_store_dwordx4 v[84:87], v2, s[32:35], s58 offen offset:1024
  v_pk_mul_f32 v[72:73], v[40:41], v[40:41]
  v_pk_mul_f32 v[74:75], v[42:43], v[42:43]
  v_pk_fma_f32 v[72:73], v[72:73], v[64:65], v[66:67] op_sel_hi:[1,0,0]
  v_pk_fma_f32 v[74:75], v[74:75], v[64:65], v[66:67] op_sel_hi:[1,0,0]
  v_pk_mul_f32 v[72:73], v[72:73], v[40:41]
  v_pk_mul_f32 v[74:75], v[74:75], v[42:43]
  v_exp_f32 v72, v72
  v_exp_f32 v73, v73
  v_exp_f32 v74, v74
  v_exp_f32 v75, v75
  v_pk_add_f32 v[72:73], v[72:73], v[68:69] op_sel_hi:[1,0]
  v_pk_add_f32 v[74:75], v[74:75], v[68:69] op_sel_hi:[1,0]
  v_rcp_f32 v72, v72
  v_rcp_f32 v73, v73
  v_rcp_f32 v74, v74
  v_rcp_f32 v75, v75
  v_pk_mul_f32 v[40:41], v[40:41], v[72:73]
  v_pk_mul_f32 v[42:43], v[42:43], v[74:75]
  v_cvt_pk_bf16_f32 v88, v40, v41
  v_cvt_pk_bf16_f32 v89, v42, v43
  v_pk_mul_f32 v[76:77], v[48:49], v[48:49]
  v_pk_mul_f32 v[78:79], v[50:51], v[50:51]
  v_pk_fma_f32 v[76:77], v[76:77], v[64:65], v[66:67] op_sel_hi:[1,0,0]
  v_pk_fma_f32 v[78:79], v[78:79], v[64:65], v[66:67] op_sel_hi:[1,0,0]
  v_pk_mul_f32 v[76:77], v[76:77], v[48:49]
  v_pk_mul_f32 v[78:79], v[78:79], v[50:51]
  v_exp_f32 v76, v76
  v_exp_f32 v77, v77
  v_exp_f32 v78, v78
  v_exp_f32 v79, v79
  v_pk_add_f32 v[76:77], v[76:77], v[68:69] op_sel_hi:[1,0]
  v_pk_add_f32 v[78:79], v[78:79], v[68:69] op_sel_hi:[1,0]
  v_rcp_f32 v76, v76
  v_rcp_f32 v77, v77
  v_rcp_f32 v78, v78
  v_rcp_f32 v79, v79
  v_pk_mul_f32 v[48:49], v[48:49], v[76:77]
  v_pk_mul_f32 v[50:51], v[50:51], v[78:79]
  v_cvt_pk_bf16_f32 v90, v48, v49
  v_cvt_pk_bf16_f32 v91, v50, v51
  buffer_store_dwordx4 v[88:91], v2, s[32:35], s58 offen offset:2048
  v_pk_mul_f32 v[72:73], v[56:57], v[56:57]
  v_pk_mul_f32 v[74:75], v[58:59], v[58:59]
  v_pk_fma_f32 v[72:73], v[72:73], v[64:65], v[66:67] op_sel_hi:[1,0,0]
  v_pk_fma_f32 v[74:75], v[74:75], v[64:65], v[66:67] op_sel_hi:[1,0,0]
  v_pk_mul_f32 v[72:73], v[72:73], v[56:57]
  v_pk_mul_f32 v[74:75], v[74:75], v[58:59]
  v_exp_f32 v72, v72
  v_exp_f32 v73, v73
  v_exp_f32 v74, v74
  v_exp_f32 v75, v75
  v_pk_add_f32 v[72:73], v[72:73], v[68:69] op_sel_hi:[1,0]
  v_pk_add_f32 v[74:75], v[74:75], v[68:69] op_sel_hi:[1,0]
  v_rcp_f32 v72, v72
  v_rcp_f32 v73, v73
  v_rcp_f32 v74, v74
  v_rcp_f32 v75, v75
  v_pk_mul_f32 v[56:57], v[56:57], v[72:73]
  v_pk_mul_f32 v[58:59], v[58:59], v[74:75]
  v_cvt_pk_bf16_f32 v92, v56, v57
  v_cvt_pk_bf16_f32 v93, v58, v59
  buffer_store_dwordx2 v[92:93], v2, s[32:35], s59 offen
  v_pk_mul_f32 v[76:77], v[12:13], v[12:13]
  v_pk_mul_f32 v[78:79], v[14:15], v[14:15]
  v_pk_fma_f32 v[76:77], v[76:77], v[64:65], v[66:67] op_sel_hi:[1,0,0]
  v_pk_fma_f32 v[78:79], v[78:79], v[64:65], v[66:67] op_sel_hi:[1,0,0]
  v_pk_mul_f32 v[76:77], v[76:77], v[12:13]
  v_pk_mul_f32 v[78:79], v[78:79], v[14:15]
  v_exp_f32 v76, v76
  v_exp_f32 v77, v77
  v_exp_f32 v78, v78
  v_exp_f32 v79, v79
  v_pk_add_f32 v[76:77], v[76:77], v[68:69] op_sel_hi:[1,0]
  v_pk_add_f32 v[78:79], v[78:79], v[68:69] op_sel_hi:[1,0]
  v_rcp_f32 v76, v76
  v_rcp_f32 v77, v77
  v_rcp_f32 v78, v78
  v_rcp_f32 v79, v79
  v_pk_mul_f32 v[12:13], v[12:13], v[76:77]
  v_pk_mul_f32 v[14:15], v[14:15], v[78:79]
  v_cvt_pk_bf16_f32 v96, v12, v13
  v_cvt_pk_bf16_f32 v97, v14, v15
  v_pk_mul_f32 v[72:73], v[20:21], v[20:21]
  v_pk_mul_f32 v[74:75], v[22:23], v[22:23]
  v_pk_fma_f32 v[72:73], v[72:73], v[64:65], v[66:67] op_sel_hi:[1,0,0]
  v_pk_fma_f32 v[74:75], v[74:75], v[64:65], v[66:67] op_sel_hi:[1,0,0]
  v_pk_mul_f32 v[72:73], v[72:73], v[20:21]
  v_pk_mul_f32 v[74:75], v[74:75], v[22:23]
  v_exp_f32 v72, v72
  v_exp_f32 v73, v73
  v_exp_f32 v74, v74
  v_exp_f32 v75, v75
  v_pk_add_f32 v[72:73], v[72:73], v[68:69] op_sel_hi:[1,0]
  v_pk_add_f32 v[74:75], v[74:75], v[68:69] op_sel_hi:[1,0]
  v_rcp_f32 v72, v72
  v_rcp_f32 v73, v73
  v_rcp_f32 v74, v74
  v_rcp_f32 v75, v75
  v_pk_mul_f32 v[20:21], v[20:21], v[72:73]
  v_pk_mul_f32 v[22:23], v[22:23], v[74:75]
  v_cvt_pk_bf16_f32 v98, v20, v21
  v_cvt_pk_bf16_f32 v99, v22, v23
  buffer_store_dwordx4 v[96:99], v2, s[32:35], s60 offen offset:0
  v_pk_mul_f32 v[76:77], v[28:29], v[28:29]
  v_pk_mul_f32 v[78:79], v[30:31], v[30:31]
  v_pk_fma_f32 v[76:77], v[76:77], v[64:65], v[66:67] op_sel_hi:[1,0,0]
  v_pk_fma_f32 v[78:79], v[78:79], v[64:65], v[66:67] op_sel_hi:[1,0,0]
  v_pk_mul_f32 v[76:77], v[76:77], v[28:29]
  v_pk_mul_f32 v[78:79], v[78:79], v[30:31]
  v_exp_f32 v76, v76
  v_exp_f32 v77, v77
  v_exp_f32 v78, v78
  v_exp_f32 v79, v79
  v_pk_add_f32 v[76:77], v[76:77], v[68:69] op_sel_hi:[1,0]
  v_pk_add_f32 v[78:79], v[78:79], v[68:69] op_sel_hi:[1,0]
  v_rcp_f32 v76, v76
  v_rcp_f32 v77, v77
  v_rcp_f32 v78, v78
  v_rcp_f32 v79, v79
  v_pk_mul_f32 v[28:29], v[28:29], v[76:77]
  v_pk_mul_f32 v[30:31], v[30:31], v[78:79]
  v_cvt_pk_bf16_f32 v100, v28, v29
  v_cvt_pk_bf16_f32 v101, v30, v31
  v_pk_mul_f32 v[72:73], v[36:37], v[36:37]
  v_pk_mul_f32 v[74:75], v[38:39], v[38:39]
  v_pk_fma_f32 v[72:73], v[72:73], v[64:65], v[66:67] op_sel_hi:[1,0,0]
  v_pk_fma_f32 v[74:75], v[74:75], v[64:65], v[66:67] op_sel_hi:[1,0,0]
  v_pk_mul_f32 v[72:73], v[72:73], v[36:37]
  v_pk_mul_f32 v[74:75], v[74:75], v[38:39]
  v_exp_f32 v72, v72
  v_exp_f32 v73, v73
  v_exp_f32 v74, v74
  v_exp_f32 v75, v75
  v_pk_add_f32 v[72:73], v[72:73], v[68:69] op_sel_hi:[1,0]
  v_pk_add_f32 v[74:75], v[74:75], v[68:69] op_sel_hi:[1,0]
  v_rcp_f32 v72, v72
  v_rcp_f32 v73, v73
  v_rcp_f32 v74, v74
  v_rcp_f32 v75, v75
  v_pk_mul_f32 v[36:37], v[36:37], v[72:73]
  v_pk_mul_f32 v[38:39], v[38:39], v[74:75]
  v_cvt_pk_bf16_f32 v102, v36, v37
  v_cvt_pk_bf16_f32 v103, v38, v39
  buffer_store_dwordx4 v[100:103], v2, s[32:35], s60 offen offset:1024
  v_pk_mul_f32 v[76:77], v[44:45], v[44:45]
  v_pk_mul_f32 v[78:79], v[46:47], v[46:47]
  v_pk_fma_f32 v[76:77], v[76:77], v[64:65], v[66:67] op_sel_hi:[1,0,0]
  v_pk_fma_f32 v[78:79], v[78:79], v[64:65], v[66:67] op_sel_hi:[1,0,0]
  v_pk_mul_f32 v[76:77], v[76:77], v[44:45]
  v_pk_mul_f32 v[78:79], v[78:79], v[46:47]
  v_exp_f32 v76, v76
  v_exp_f32 v77, v77
  v_exp_f32 v78, v78
  v_exp_f32 v79, v79
  v_pk_add_f32 v[76:77], v[76:77], v[68:69] op_sel_hi:[1,0]
  v_pk_add_f32 v[78:79], v[78:79], v[68:69] op_sel_hi:[1,0]
  v_rcp_f32 v76, v76
  v_rcp_f32 v77, v77
  v_rcp_f32 v78, v78
  v_rcp_f32 v79, v79
  v_pk_mul_f32 v[44:45], v[44:45], v[76:77]
  v_pk_mul_f32 v[46:47], v[46:47], v[78:79]
  v_cvt_pk_bf16_f32 v104, v44, v45
  v_cvt_pk_bf16_f32 v105, v46, v47
  v_pk_mul_f32 v[72:73], v[52:53], v[52:53]
  v_pk_mul_f32 v[74:75], v[54:55], v[54:55]
  v_pk_fma_f32 v[72:73], v[72:73], v[64:65], v[66:67] op_sel_hi:[1,0,0]
  v_pk_fma_f32 v[74:75], v[74:75], v[64:65], v[66:67] op_sel_hi:[1,0,0]
  v_pk_mul_f32 v[72:73], v[72:73], v[52:53]
  v_pk_mul_f32 v[74:75], v[74:75], v[54:55]
  v_exp_f32 v72, v72
  v_exp_f32 v73, v73
  v_exp_f32 v74, v74
  v_exp_f32 v75, v75
  v_pk_add_f32 v[72:73], v[72:73], v[68:69] op_sel_hi:[1,0]
  v_pk_add_f32 v[74:75], v[74:75], v[68:69] op_sel_hi:[1,0]
  v_rcp_f32 v72, v72
  v_rcp_f32 v73, v73
  v_rcp_f32 v74, v74
  v_rcp_f32 v75, v75
  v_pk_mul_f32 v[52:53], v[52:53], v[72:73]
  v_pk_mul_f32 v[54:55], v[54:55], v[74:75]
  v_cvt_pk_bf16_f32 v106, v52, v53
  v_cvt_pk_bf16_f32 v107, v54, v55
  buffer_store_dwordx4 v[104:107], v2, s[32:35], s60 offen offset:2048
  v_pk_mul_f32 v[76:77], v[60:61], v[60:61]
  v_pk_mul_f32 v[78:79], v[62:63], v[62:63]
  v_pk_fma_f32 v[76:77], v[76:77], v[64:65], v[66:67] op_sel_hi:[1,0,0]
  v_pk_fma_f32 v[78:79], v[78:79], v[64:65], v[66:67] op_sel_hi:[1,0,0]
  v_pk_mul_f32 v[76:77], v[76:77], v[60:61]
  v_pk_mul_f32 v[78:79], v[78:79], v[62:63]
  v_exp_f32 v76, v76
  v_exp_f32 v77, v77
  v_exp_f32 v78, v78
  v_exp_f32 v79, v79
  v_pk_add_f32 v[76:77], v[76:77], v[68:69] op_sel_hi:[1,0]
  v_pk_add_f32 v[78:79], v[78:79], v[68:69] op_sel_hi:[1,0]
  v_rcp_f32 v76, v76
  v_rcp_f32 v77, v77
  v_rcp_f32 v78, v78
  v_rcp_f32 v79, v79
  v_pk_mul_f32 v[60:61], v[60:61], v[76:77]
  v_pk_mul_f32 v[62:63], v[62:63], v[78:79]
  v_cvt_pk_bf16_f32 v108, v60, v61
  v_cvt_pk_bf16_f32 v109, v62, v63
  buffer_store_dwordx2 v[108:109], v2, s[32:35], s61 offen
  s_waitcnt vmcnt(0) lgkmcnt(0)
  s_cmp_eq_u32 s100, 1
  s_cbranch_scc1 L_sigp_67
  buffer_wbl2 sc1
  s_waitcnt vmcnt(0)
L_sigp_67:
  s_barrier
  s_cmp_lg_u32 s6, 0
  s_cbranch_scc1 L_sig_66
  s_lshl_b32 s57, s52, 2
  s_add_u32 s57, s57, 8192
  v_mov_b32 v2, s98
  s_mov_b64 exec, 1
  s_cmp_eq_u32 s100, 1
  s_cbranch_scc1 L_stp_68
  buffer_store_dword v2, off, s[32:35], s57 sc1
  s_branch L_std_69
L_stp_68:
  buffer_store_dword v2, off, s[32:35], s57
L_std_69:
  s_mov_b64 exec, -1
L_sig_66:
  v_lshrrev_b32 v5, 4, v1
  v_lshlrev_b32 v5, 3, v5
  s_lshl_b32 s59, s96, 7
  buffer_load_dwordx2 v[216:217], v5, s[48:51], s59 offen offset:0
  buffer_load_dwordx2 v[218:219], v5, s[48:51], s59 offen offset:32
  buffer_load_dwordx2 v[220:221], v5, s[48:51], s59 offen offset:64
  buffer_load_dwordx2 v[222:223], v5, s[48:51], s59 offen offset:96
  s_cmp_eq_u32 s100, 1
  s_cbranch_scc1 L_acq_70
  buffer_inv sc1
  s_waitcnt vmcnt(0)
L_acq_70:
  v_and_b32 v4, 15, v1
  v_lshlrev_b32 v4, 10, v4
  v_lshrrev_b32 v5, 4, v1
  v_lshl_add_u32 v4, v5, 4, v4
  s_lshl_b32 s59, s95, 16
  s_lshl_b32 s60, s6, 14
  s_add_u32 s59, s59, s60
  s_lshl_b32 s60, s96, 7
  s_add_u32 s59, s59, s60
  s_add_u32 s59, s59, s85
  buffer_load_dwordx4 v[208:211], v4, s[32:35], s59 offen sc1
  buffer_load_dwordx4 v[212:215], v4, s[32:35], s59 offen offset:64 sc1
  s_lshl_b32 s62, s4, 5
  s_lshl_b32 s61, s93, 4
  s_add_u32 s62, s62, s61
  s_lshl_b32 s57, s62, 2
  s_add_u32 s57, s57, 8192
  v_min_u32 v2, 15, v1
  v_lshlrev_b32 v2, 2, v2
  s_mov_b32 s56, 262144
L_poll_71:
  buffer_load_dword v3, v2, s[32:35], s57 offen sc1
  s_waitcnt vmcnt(0)
  v_cmp_ne_u32 vcc, s98, v3
  s_cbranch_vccz L_polld_72
  s_sub_u32 s56, s56, 1
  s_cbranch_scc1 L_polt_73
  s_sleep 1
  s_branch L_poll_71
L_polt_73:
L_polld_72:
  s_cmp_eq_u32 s100, 1
  s_cbranch_scc1 L_acq_74
  buffer_inv sc1
  s_waitcnt vmcnt(0)
L_acq_74:
  v_lshlrev_b32 v2, 4, v1
  s_lshl_b32 s57, s4, 4
  s_lshl_b32 s58, s95, 2
  s_add_u32 s57, s57, s58
  s_mul_i32 s57, s57, 57344
  s_mul_i32 s58, s86, 14336
  s_add_u32 s57, s57, s58
  s_add_u32 s57, s57, s72
  s_add_u32 s58, s6, 1
  s_and_b32 s58, s58, 3
  s_mul_i32 s58, s58, 57344
  s_add_u32 s76, s58, s57
  s_add_u32 s58, s6, 2
  s_and_b32 s58, s58, 3
  s_mul_i32 s58, s58, 57344
  s_add_u32 s77, s58, s57
  s_add_u32 s58, s6, 3
  s_and_b32 s58, s58, 3
  s_mul_i32 s58, s58, 57344
  s_add_u32 s78, s58, s57
  s_add_u32 s58, s6, 4
  s_and_b32 s58, s58, 3
  s_mul_i32 s58, s58, 57344
  s_add_u32 s79, s58, s57
  buffer_load_dwordx4 v[40:43], v2, s[32:35], s76 offen offset:0 sc1
  buffer_load_dwordx4 v[44:47], v2, s[32:35], s76 offen offset:1024 sc1
  buffer_load_dwordx4 v[48:51], v2, s[32:35], s76 offen offset:2048 sc1
  buffer_load_dwordx4 v[52:55], v2, s[32:35], s76 offen offset:3072 sc1
  s_add_u32 s76, s76, 4096
  buffer_load_dwordx4 v[56:59], v2, s[32:35], s76 offen offset:0 sc1
  buffer_load_dwordx4 v[60:63], v2, s[32:35], s76 offen offset:1024 sc1
  buffer_load_dwordx4 v[64:67], v2, s[32:35], s76 offen offset:2048 sc1
  buffer_load_dwordx4 v[68:71], v2, s[32:35], s76 offen offset:3072 sc1
  s_add_u32 s76, s76, 4096
  buffer_load_dwordx4 v[72:75], v2, s[32:35], s76 offen offset:0 sc1
  buffer_load_dwordx4 v[76:79], v2, s[32:35], s76 offen offset:1024 sc1
  buffer_load_dwordx4 v[80:83], v2, s[32:35], s76 offen offset:2048 sc1
  buffer_load_dwordx4 v[84:87], v2, s[32:35], s76 offen offset:3072 sc1
  s_add_u32 s76, s76, 4096
  buffer_load_dwordx4 v[88:91], v2, s[32:35], s76 offen offset:0 sc1
  buffer_load_dwordx4 v[92:95], v2, s[32:35], s76 offen offset:1024 sc1
  v_lshlrev_b32 v3, 4, v1
  s_add_u32 s58, s6, 1
  s_and_b32 s58, s58, 3
  s_mul_i32 s58, s58, 12288
  s_add_u32 s58, s58, 122880
  v_add_u32 v5, s58, v3
  s_add_u32 s58, s6, 2
  s_and_b32 s58, s58, 3
  s_mul_i32 s58, s58, 12288
  s_add_u32 s58, s58, 118784
  v_add_u32 v6, s58, v3
  s_add_u32 s58, s6, 3
  s_and_b32 s58, s58, 3
  s_mul_i32 s58, s58, 12288
  s_add_u32 s58, s58, 114688
  v_add_u32 v7, s58, v3
  s_mul_i32 s58, s6, 12288
  s_add_u32 s58, s58, 114688
  v_add_u32 v4, s58, v3
  s_waitcnt vmcnt(13)
  v_mfma_f32_16x16x32_bf16 v[8:11], a[0:3], v[40:43], 0
  v_mfma_f32_16x16x32_bf16 v[12:15], a[4:7], v[40:43], 0
  buffer_load_dwordx4 v[96:99], v2, s[32:35], s77 offen offset:0 sc1
  v_mfma_f32_16x16x32_bf16 v[16:19], a[8:11], v[40:43], 0
  v_mfma_f32_16x16x32_bf16 v[20:23], a[12:15], v[40:43], 0
  s_waitcnt vmcnt(13)
  v_mfma_f32_16x16x32_bf16 v[8:11], a[16:19], v[44:47], v[8:11]
  v_mfma_f32_16x16x32_bf16 v[12:15], a[20:23], v[44:47], v[12:15]
  buffer_load_dwordx4 v[100:103], v2, s[32:35], s77 offen offset:1024 sc1
  v_mfma_f32_16x16x32_bf16 v[16:19], a[24:27], v[44:47], v[16:19]
  v_mfma_f32_16x16x32_bf16 v[20:23], a[28:31], v[44:47], v[20:23]
  s_waitcnt vmcnt(13)
  v_mfma_f32_16x16x32_bf16 v[8:11], a[32:35], v[48:51], v[8:11]
  v_mfma_f32_16x16x32_bf16 v[12:15], a[36:39], v[48:51], v[12:15]
  buffer_load_dwordx4 v[104:107], v2, s[32:35], s77 offen offset:2048 sc1
  v_mfma_f32_16x16x32_bf16 v[16:19], a[40:43], v[48:51], v[16:19]
  v_mfma_f32_16x16x32_bf16 v[20:23], a[44:47], v[48:51], v[20:23]
  s_waitcnt vmcnt(13)
  v_mfma_f32_16x16x32_bf16 v[8:11], a[48:51], v[52:55], v[8:11]
  v_mfma_f32_16x16x32_bf16 v[12:15], a[52:55], v[52:55], v[12:15]
  buffer_load_dwordx4 v[108:111], v2, s[32:35], s77 offen offset:3072 sc1
  v_mfma_f32_16x16x32_bf16 v[16:19], a[56:59], v[52:55], v[16:19]
  v_mfma_f32_16x16x32_bf16 v[20:23], a[60:63], v[52:55], v[20:23]
  s_waitcnt vmcnt(13)
  v_mfma_f32_16x16x32_bf16 v[8:11], a[64:67], v[56:59], v[8:11]
  v_mfma_f32_16x16x32_bf16 v[12:15], a[68:71], v[56:59], v[12:15]
  s_add_u32 s77, s77, 4096
  buffer_load_dwordx4 v[112:115], v2, s[32:35], s77 offen offset:0 sc1
  v_mfma_f32_16x16x32_bf16 v[16:19], a[72:75], v[56:59], v[16:19]
  v_mfma_f32_16x16x32_bf16 v[20:23], a[76:79], v[56:59], v[20:23]
  s_waitcnt vmcnt(13)
  v_mfma_f32_16x16x32_bf16 v[8:11], a[80:83], v[60:63], v[8:11]
  v_mfma_f32_16x16x32_bf16 v[12:15], a[84:87], v[60:63], v[12:15]
  buffer_load_dwordx4 v[116:119], v2, s[32:35], s77 offen offset:1024 sc1
  v_mfma_f32_16x16x32_bf16 v[16:19], a[88:91], v[60:63], v[16:19]
  v_mfma_f32_16x16x32_bf16 v[20:23], a[92:95], v[60:63], v[20:23]
  s_waitcnt vmcnt(13)
  v_mfma_f32_16x16x32_bf16 v[8:11], a[96:99], v[64:67], v[8:11]
  v_mfma_f32_16x16x32_bf16 v[12:15], a[100:103], v[64:67], v[12:15]
  buffer_load_dwordx4 v[120:123], v2, s[32:35], s77 offen offset:2048 sc1
  v_mfma_f32_16x16x32_bf16 v[16:19], a[104:107], v[64:67], v[16:19]
  v_mfma_f32_16x16x32_bf16 v[20:23], a[108:111], v[64:67], v[20:23]
  s_waitcnt vmcnt(13)
  v_mfma_f32_16x16x32_bf16 v[8:11], a[112:115], v[68:71], v[8:11]
  v_mfma_f32_16x16x32_bf16 v[12:15], a[116:119], v[68:71], v[12:15]
  buffer_load_dwordx4 v[124:127], v2, s[32:35], s77 offen offset:3072 sc1
  v_mfma_f32_16x16x32_bf16 v[16:19], a[120:123], v[68:71], v[16:19]
  v_mfma_f32_16x16x32_bf16 v[20:23], a[124:127], v[68:71], v[20:23]
  s_waitcnt vmcnt(13)
  v_mfma_f32_16x16x32_bf16 v[8:11], a[128:131], v[72:75], v[8:11]
  v_mfma_f32_16x16x32_bf16 v[12:15], a[132:135], v[72:75], v[12:15]
  s_add_u32 s77, s77, 4096
  buffer_load_dwordx4 v[128:131], v2, s[32:35], s77 offen offset:0 sc1
  v_mfma_f32_16x16x32_bf16 v[16:19], a[136:139], v[72:75], v[16:19]
  v_mfma_f32_16x16x32_bf16 v[20:23], a[140:143], v[72:75], v[20:23]
  s_waitcnt vmcnt(13)
  v_mfma_f32_16x16x32_bf16 v[8:11], a[144:147], v[76:79], v[8:11]
  v_mfma_f32_16x16x32_bf16 v[12:15], a[148:151], v[76:79], v[12:15]
  buffer_load_dwordx4 v[132:135], v2, s[32:35], s77 offen offset:1024 sc1
  v_mfma_f32_16x16x32_bf16 v[16:19], a[152:155], v[76:79], v[16:19]
  v_mfma_f32_16x16x32_bf16 v[20:23], a[156:159], v[76:79], v[20:23]
  s_waitcnt vmcnt(13)
  v_mfma_f32_16x16x32_bf16 v[8:11], a[160:163], v[80:83], v[8:11]
  v_mfma_f32_16x16x32_bf16 v[12:15], a[164:167], v[80:83], v[12:15]
  buffer_load_dwordx4 v[136:139], v2, s[32:35], s77 offen offset:2048 sc1
  v_mfma_f32_16x16x32_bf16 v[16:19], a[168:171], v[80:83], v[16:19]
  v_mfma_f32_16x16x32_bf16 v[20:23], a[172:175], v[80:83], v[20:23]
  s_waitcnt vmcnt(13)
  v_mfma_f32_16x16x32_bf16 v[8:11], a[176:179], v[84:87], v[8:11]
  v_mfma_f32_16x16x32_bf16 v[12:15], a[180:183], v[84:87], v[12:15]
  buffer_load_dwordx4 v[140:143], v2, s[32:35], s77 offen offset:3072 sc1
  v_mfma_f32_16x16x32_bf16 v[16:19], a[184:187], v[84:87], v[16:19]
  v_mfma_f32_16x16x32_bf16 v[20:23], a[188:191], v[84:87], v[20:23]
  s_waitcnt vmcnt(13)
  v_mfma_f32_16x16x32_bf16 v[8:11], a[192:195], v[88:91], v[8:11]
  v_mfma_f32_16x16x32_bf16 v[12:15], a[196:199], v[88:91], v[12:15]
  s_add_u32 s77, s77, 4096
  buffer_load_dwordx4 v[144:147], v2, s[32:35], s77 offen offset:0 sc1
  v_mfma_f32_16x16x32_bf16 v[16:19], a[200:203], v[88:91], v[16:19]
  v_mfma_f32_16x16x32_bf16 v[20:23], a[204:207], v[88:91], v[20:23]
  s_waitcnt vmcnt(13)
  v_mfma_f32_16x16x32_bf16 v[8:11], a[208:211], v[92:95], v[8:11]
  v_mfma_f32_16x16x32_bf16 v[12:15], a[212:215], v[92:95], v[12:15]
  buffer_load_dwordx4 v[148:151], v2, s[32:35], s77 offen offset:1024 sc1
  v_mfma_f32_16x16x32_bf16 v[16:19], a[216:219], v[92:95], v[16:19]
  v_mfma_f32_16x16x32_bf16 v[20:23], a[220:223], v[92:95], v[20:23]
  s_waitcnt vmcnt(13)
  v_mfma_f32_16x16x32_bf16 v[24:27], a[0:3], v[96:99], 0
  v_mfma_f32_16x16x32_bf16 v[28:31], a[4:7], v[96:99], 0
  buffer_load_dwordx4 v[152:155], v2, s[32:35], s78 offen offset:0 sc1
  v_mfma_f32_16x16x32_bf16 v[32:35], a[8:11], v[96:99], 0
  v_mfma_f32_16x16x32_bf16 v[36:39], a[12:15], v[96:99], 0
  s_waitcnt vmcnt(13)
  v_mfma_f32_16x16x32_bf16 v[24:27], a[16:19], v[100:103], v[24:27]
  v_mfma_f32_16x16x32_bf16 v[28:31], a[20:23], v[100:103], v[28:31]
  buffer_load_dwordx4 v[156:159], v2, s[32:35], s78 offen offset:1024 sc1
  v_mfma_f32_16x16x32_bf16 v[32:35], a[24:27], v[100:103], v[32:35]
  v_mfma_f32_16x16x32_bf16 v[36:39], a[28:31], v[100:103], v[36:39]
  ds_write_b128 v5, v[8:11] offset:0
  s_waitcnt vmcnt(13)
  v_mfma_f32_16x16x32_bf16 v[24:27], a[32:35], v[104:107], v[24:27]
  v_mfma_f32_16x16x32_bf16 v[28:31], a[36:39], v[104:107], v[28:31]
  buffer_load_dwordx4 v[160:163], v2, s[32:35], s78 offen offset:2048 sc1
  v_mfma_f32_16x16x32_bf16 v[32:35], a[40:43], v[104:107], v[32:35]
  v_mfma_f32_16x16x32_bf16 v[36:39], a[44:47], v[104:107], v[36:39]
  ds_write_b128 v5, v[12:15] offset:1024
  s_waitcnt vmcnt(13)
  v_mfma_f32_16x16x32_bf16 v[24:27], a[48:51], v[108:111], v[24:27]
  v_mfma_f32_16x16x32_bf16 v[28:31], a[52:55], v[108:111], v[28:31]
  buffer_load_dwordx4 v[164:167], v2, s[32:35], s78 offen offset:3072 sc1
  v_mfma_f32_16x16x32_bf16 v[32:35], a[56:59], v[108:111], v[32:35]
  v_mfma_f32_16x16x32_bf16 v[36:39], a[60:63], v[108:111], v[36:39]
  ds_write_b128 v5, v[16:19] offset:2048
  s_waitcnt vmcnt(13)
  v_mfma_f32_16x16x32_bf16 v[24:27], a[64:67], v[112:115], v[24:27]
  v_mfma_f32_16x16x32_bf16 v[28:31], a[68:71], v[112:115], v[28:31]
  s_add_u32 s78, s78, 4096
  buffer_load_dwordx4 v[168:171], v2, s[32:35], s78 offen offset:0 sc1
  v_mfma_f32_16x16x32_bf16 v[32:35], a[72:75], v[112:115], v[32:35]
  v_mfma_f32_16x16x32_bf16 v[36:39], a[76:79], v[112:115], v[36:39]
  ds_write_b128 v5, v[20:23] offset:3072
  s_waitcnt vmcnt(13)
  v_mfma_f32_16x16x32_bf16 v[24:27], a[80:83], v[116:119], v[24:27]
  v_mfma_f32_16x16x32_bf16 v[28:31], a[84:87], v[116:119], v[28:31]
  buffer_load_dwordx4 v[172:175], v2, s[32:35], s78 offen offset:1024 sc1
  v_mfma_f32_16x16x32_bf16 v[32:35], a[88:91], v[116:119], v[32:35]
  v_mfma_f32_16x16x32_bf16 v[36:39], a[92:95], v[116:119], v[36:39]
  s_waitcnt vmcnt(13)
  v_mfma_f32_16x16x32_bf16 v[24:27], a[96:99], v[120:123], v[24:27]
  v_mfma_f32_16x16x32_bf16 v[28:31], a[100:103], v[120:123], v[28:31]
  buffer_load_dwordx4 v[176:179], v2, s[32:35], s78 offen offset:2048 sc1
  v_mfma_f32_16x16x32_bf16 v[32:35], a[104:107], v[120:123], v[32:35]
  v_mfma_f32_16x16x32_bf16 v[36:39], a[108:111], v[120:123], v[36:39]
  s_waitcnt vmcnt(13)
  v_mfma_f32_16x16x32_bf16 v[24:27], a[112:115], v[124:127], v[24:27]
  v_mfma_f32_16x16x32_bf16 v[28:31], a[116:119], v[124:127], v[28:31]
  buffer_load_dwordx4 v[180:183], v2, s[32:35], s78 offen offset:3072 sc1
  v_mfma_f32_16x16x32_bf16 v[32:35], a[120:123], v[124:127], v[32:35]
  v_mfma_f32_16x16x32_bf16 v[36:39], a[124:127], v[124:127], v[36:39]
  s_waitcnt vmcnt(13)
  v_mfma_f32_16x16x32_bf16 v[24:27], a[128:131], v[128:131], v[24:27]
  v_mfma_f32_16x16x32_bf16 v[28:31], a[132:135], v[128:131], v[28:31]
  s_add_u32 s78, s78, 4096
  buffer_load_dwordx4 v[184:187], v2, s[32:35], s78 offen offset:0 sc1
  v_mfma_f32_16x16x32_bf16 v[32:35], a[136:139], v[128:131], v[32:35]
  v_mfma_f32_16x16x32_bf16 v[36:39], a[140:143], v[128:131], v[36:39]
  s_waitcnt vmcnt(13)
  v_mfma_f32_16x16x32_bf16 v[24:27], a[144:147], v[132:135], v[24:27]
  v_mfma_f32_16x16x32_bf16 v[28:31], a[148:151], v[132:135], v[28:31]
  buffer_load_dwordx4 v[188:191], v2, s[32:35], s78 offen offset:1024 sc1
  v_mfma_f32_16x16x32_bf16 v[32:35], a[152:155], v[132:135], v[32:35]
  v_mfma_f32_16x16x32_bf16 v[36:39], a[156:159], v[132:135], v[36:39]
  s_waitcnt vmcnt(13)
  v_mfma_f32_16x16x32_bf16 v[24:27], a[160:163], v[136:139], v[24:27]
  v_mfma_f32_16x16x32_bf16 v[28:31], a[164:167], v[136:139], v[28:31]
  buffer_load_dwordx4 v[192:195], v2, s[32:35], s78 offen offset:2048 sc1
  v_mfma_f32_16x16x32_bf16 v[32:35], a[168:171], v[136:139], v[32:35]
  v_mfma_f32_16x16x32_bf16 v[36:39], a[172:175], v[136:139], v[36:39]
  s_waitcnt vmcnt(13)
  v_mfma_f32_16x16x32_bf16 v[24:27], a[176:179], v[140:143], v[24:27]
  v_mfma_f32_16x16x32_bf16 v[28:31], a[180:183], v[140:143], v[28:31]
  buffer_load_dwordx4 v[196:199], v2, s[32:35], s78 offen offset:3072 sc1
  v_mfma_f32_16x16x32_bf16 v[32:35], a[184:187], v[140:143], v[32:35]
  v_mfma_f32_16x16x32_bf16 v[36:39], a[188:191], v[140:143], v[36:39]
  s_waitcnt vmcnt(13)
  v_mfma_f32_16x16x32_bf16 v[24:27], a[192:195], v[144:147], v[24:27]
  v_mfma_f32_16x16x32_bf16 v[28:31], a[196:199], v[144:147], v[28:31]
  s_add_u32 s78, s78, 4096
  buffer_load_dwordx4 v[200:203], v2, s[32:35], s78 offen offset:0 sc1
  v_mfma_f32_16x16x32_bf16 v[32:35], a[200:203], v[144:147], v[32:35]
  v_mfma_f32_16x16x32_bf16 v[36:39], a[204:207], v[144:147], v[36:39]
  s_waitcnt vmcnt(13)
  v_mfma_f32_16x16x32_bf16 v[24:27], a[208:211], v[148:151], v[24:27]
  v_mfma_f32_16x16x32_bf16 v[28:31], a[212:215], v[148:151], v[28:31]
  buffer_load_dwordx4 v[204:207], v2, s[32:35], s78 offen offset:1024 sc1
  v_mfma_f32_16x16x32_bf16 v[32:35], a[216:219], v[148:151], v[32:35]
  v_mfma_f32_16x16x32_bf16 v[36:39], a[220:223], v[148:151], v[36:39]
  s_waitcnt vmcnt(13)
  v_mfma_f32_16x16x32_bf16 v[8:11], a[0:3], v[152:155], 0
  v_mfma_f32_16x16x32_bf16 v[12:15], a[4:7], v[152:155], 0
  buffer_load_dwordx4 v[40:43], v2, s[32:35], s79 offen offset:0 sc1
  v_mfma_f32_16x16x32_bf16 v[16:19], a[8:11], v[152:155], 0
  v_mfma_f32_16x16x32_bf16 v[20:23], a[12:15], v[152:155], 0
  s_waitcnt vmcnt(13)
  v_mfma_f32_16x16x32_bf16 v[8:11], a[16:19], v[156:159], v[8:11]
  v_mfma_f32_16x16x32_bf16 v[12:15], a[20:23], v[156:159], v[12:15]
  buffer_load_dwordx4 v[44:47], v2, s[32:35], s79 offen offset:1024 sc1
  v_mfma_f32_16x16x32_bf16 v[16:19], a[24:27], v[156:159], v[16:19]
  v_mfma_f32_16x16x32_bf16 v[20:23], a[28:31], v[156:159], v[20:23]
  ds_write_b128 v6, v[24:27] offset:0
  s_waitcnt vmcnt(13)
  v_mfma_f32_16x16x32_bf16 v[8:11], a[32:35], v[160:163], v[8:11]
  v_mfma_f32_16x16x32_bf16 v[12:15], a[36:39], v[160:163], v[12:15]
  buffer_load_dwordx4 v[48:51], v2, s[32:35], s79 offen offset:2048 sc1
  v_mfma_f32_16x16x32_bf16 v[16:19], a[40:43], v[160:163], v[16:19]
  v_mfma_f32_16x16x32_bf16 v[20:23], a[44:47], v[160:163], v[20:23]
  ds_write_b128 v6, v[28:31] offset:1024
  s_waitcnt vmcnt(13)
  v_mfma_f32_16x16x32_bf16 v[8:11], a[48:51], v[164:167], v[8:11]
  v_mfma_f32_16x16x32_bf16 v[12:15], a[52:55], v[164:167], v[12:15]
  buffer_load_dwordx4 v[52:55], v2, s[32:35], s79 offen offset:3072 sc1
  v_mfma_f32_16x16x32_bf16 v[16:19], a[56:59], v[164:167], v[16:19]
  v_mfma_f32_16x16x32_bf16 v[20:23], a[60:63], v[164:167], v[20:23]
  ds_write_b128 v6, v[32:35] offset:2048
  s_waitcnt vmcnt(13)
  v_mfma_f32_16x16x32_bf16 v[8:11], a[64:67], v[168:171], v[8:11]
  v_mfma_f32_16x16x32_bf16 v[12:15], a[68:71], v[168:171], v[12:15]
  s_add_u32 s79, s79, 4096
  buffer_load_dwordx4 v[56:59], v2, s[32:35], s79 offen offset:0 sc1
  v_mfma_f32_16x16x32_bf16 v[16:19], a[72:75], v[168:171], v[16:19]
  v_mfma_f32_16x16x32_bf16 v[20:23], a[76:79], v[168:171], v[20:23]
  ds_write_b128 v6, v[36:39] offset:3072
  s_waitcnt vmcnt(13)
  v_mfma_f32_16x16x32_bf16 v[8:11], a[80:83], v[172:175], v[8:11]
  v_mfma_f32_16x16x32_bf16 v[12:15], a[84:87], v[172:175], v[12:15]
  buffer_load_dwordx4 v[60:63], v2, s[32:35], s79 offen offset:1024 sc1
  v_mfma_f32_16x16x32_bf16 v[16:19], a[88:91], v[172:175], v[16:19]
  v_mfma_f32_16x16x32_bf16 v[20:23], a[92:95], v[172:175], v[20:23]
  s_waitcnt vmcnt(13)
  v_mfma_f32_16x16x32_bf16 v[8:11], a[96:99], v[176:179], v[8:11]
  v_mfma_f32_16x16x32_bf16 v[12:15], a[100:103], v[176:179], v[12:15]
  buffer_load_dwordx4 v[64:67], v2, s[32:35], s79 offen offset:2048 sc1
  v_mfma_f32_16x16x32_bf16 v[16:19], a[104:107], v[176:179], v[16:19]
  v_mfma_f32_16x16x32_bf16 v[20:23], a[108:111], v[176:179], v[20:23]
  s_waitcnt vmcnt(13)
  v_mfma_f32_16x16x32_bf16 v[8:11], a[112:115], v[180:183], v[8:11]
  v_mfma_f32_16x16x32_bf16 v[12:15], a[116:119], v[180:183], v[12:15]
  buffer_load_dwordx4 v[68:71], v2, s[32:35], s79 offen offset:3072 sc1
  v_mfma_f32_16x16x32_bf16 v[16:19], a[120:123], v[180:183], v[16:19]
  v_mfma_f32_16x16x32_bf16 v[20:23], a[124:127], v[180:183], v[20:23]
  s_waitcnt vmcnt(13)
  v_mfma_f32_16x16x32_bf16 v[8:11], a[128:131], v[184:187], v[8:11]
  v_mfma_f32_16x16x32_bf16 v[12:15], a[132:135], v[184:187], v[12:15]
  s_add_u32 s79, s79, 4096
  buffer_load_dwordx4 v[72:75], v2, s[32:35], s79 offen offset:0 sc1
  v_mfma_f32_16x16x32_bf16 v[16:19], a[136:139], v[184:187], v[16:19]
  v_mfma_f32_16x16x32_bf16 v[20:23], a[140:143], v[184:187], v[20:23]
  s_waitcnt vmcnt(13)
  v_mfma_f32_16x16x32_bf16 v[8:11], a[144:147], v[188:191], v[8:11]
  v_mfma_f32_16x16x32_bf16 v[12:15], a[148:151], v[188:191], v[12:15]
  buffer_load_dwordx4 v[76:79], v2, s[32:35], s79 offen offset:1024 sc1
  v_mfma_f32_16x16x32_bf16 v[16:19], a[152:155], v[188:191], v[16:19]
  v_mfma_f32_16x16x32_bf16 v[20:23], a[156:159], v[188:191], v[20:23]
  s_waitcnt vmcnt(13)
  v_mfma_f32_16x16x32_bf16 v[8:11], a[160:163], v[192:195], v[8:11]
  v_mfma_f32_16x16x32_bf16 v[12:15], a[164:167], v[192:195], v[12:15]
  buffer_load_dwordx4 v[80:83], v2, s[32:35], s79 offen offset:2048 sc1
  v_mfma_f32_16x16x32_bf16 v[16:19], a[168:171], v[192:195], v[16:19]
  v_mfma_f32_16x16x32_bf16 v[20:23], a[172:175], v[192:195], v[20:23]
  s_waitcnt vmcnt(13)
  v_mfma_f32_16x16x32_bf16 v[8:11], a[176:179], v[196:199], v[8:11]
  v_mfma_f32_16x16x32_bf16 v[12:15], a[180:183], v[196:199], v[12:15]
  buffer_load_dwordx4 v[84:87], v2, s[32:35], s79 offen offset:3072 sc1
  v_mfma_f32_16x16x32_bf16 v[16:19], a[184:187], v[196:199], v[16:19]
  v_mfma_f32_16x16x32_bf16 v[20:23], a[188:191], v[196:199], v[20:23]
  s_waitcnt vmcnt(13)
  v_mfma_f32_16x16x32_bf16 v[8:11], a[192:195], v[200:203], v[8:11]
  v_mfma_f32_16x16x32_bf16 v[12:15], a[196:199], v[200:203], v[12:15]
  s_add_u32 s79, s79, 4096
  buffer_load_dwordx4 v[88:91], v2, s[32:35], s79 offen offset:0 sc1
  v_mfma_f32_16x16x32_bf16 v[16:19], a[200:203], v[200:203], v[16:19]
  v_mfma_f32_16x16x32_bf16 v[20:23], a[204:207], v[200:203], v[20:23]
  s_waitcnt vmcnt(13)
  v_mfma_f32_16x16x32_bf16 v[8:11], a[208:211], v[204:207], v[8:11]
  v_mfma_f32_16x16x32_bf16 v[12:15], a[212:215], v[204:207], v[12:15]
  buffer_load_dwordx4 v[92:95], v2, s[32:35], s79 offen offset:1024 sc1
  v_mfma_f32_16x16x32_bf16 v[16:19], a[216:219], v[204:207], v[16:19]
  v_mfma_f32_16x16x32_bf16 v[20:23], a[220:223], v[204:207], v[20:23]
  s_waitcnt vmcnt(13)
  v_mfma_f32_16x16x32_bf16 v[24:27], a[0:3], v[40:43], 0
  v_mfma_f32_16x16x32_bf16 v[28:31], a[4:7], v[40:43], 0
  v_mfma_f32_16x16x32_bf16 v[32:35], a[8:11], v[40:43], 0
  v_mfma_f32_16x16x32_bf16 v[36:39], a[12:15], v[40:43], 0
  s_waitcnt vmcnt(12)
  v_mfma_f32_16x16x32_bf16 v[24:27], a[16:19], v[44:47], v[24:27]
  v_mfma_f32_16x16x32_bf16 v[28:31], a[20:23], v[44:47], v[28:31]
  v_mfma_f32_16x16x32_bf16 v[32:35], a[24:27], v[44:47], v[32:35]
  v_mfma_f32_16x16x32_bf16 v[36:39], a[28:31], v[44:47], v[36:39]
  ds_write_b128 v7, v[8:11] offset:0
  s_waitcnt vmcnt(11)
  v_mfma_f32_16x16x32_bf16 v[24:27], a[32:35], v[48:51], v[24:27]
  v_mfma_f32_16x16x32_bf16 v[28:31], a[36:39], v[48:51], v[28:31]
  v_mfma_f32_16x16x32_bf16 v[32:35], a[40:43], v[48:51], v[32:35]
  v_mfma_f32_16x16x32_bf16 v[36:39], a[44:47], v[48:51], v[36:39]
  ds_write_b128 v7, v[12:15] offset:1024
  s_waitcnt vmcnt(10)
  v_mfma_f32_16x16x32_bf16 v[24:27], a[48:51], v[52:55], v[24:27]
  v_mfma_f32_16x16x32_bf16 v[28:31], a[52:55], v[52:55], v[28:31]
  v_mfma_f32_16x16x32_bf16 v[32:35], a[56:59], v[52:55], v[32:35]
  v_mfma_f32_16x16x32_bf16 v[36:39], a[60:63], v[52:55], v[36:39]
  ds_write_b128 v7, v[16:19] offset:2048
  s_waitcnt vmcnt(9)
  v_mfma_f32_16x16x32_bf16 v[24:27], a[64:67], v[56:59], v[24:27]
  v_mfma_f32_16x16x32_bf16 v[28:31], a[68:71], v[56:59], v[28:31]
  v_mfma_f32_16x16x32_bf16 v[32:35], a[72:75], v[56:59], v[32:35]
  v_mfma_f32_16x16x32_bf16 v[36:39], a[76:79], v[56:59], v[36:39]
  ds_write_b128 v7, v[20:23] offset:3072
  s_waitcnt vmcnt(8)
  v_mfma_f32_16x16x32_bf16 v[24:27], a[80:83], v[60:63], v[24:27]
  v_mfma_f32_16x16x32_bf16 v[28:31], a[84:87], v[60:63], v[28:31]
  v_mfma_f32_16x16x32_bf16 v[32:35], a[88:91], v[60:63], v[32:35]
  v_mfma_f32_16x16x32_bf16 v[36:39], a[92:95], v[60:63], v[36:39]
  s_waitcnt vmcnt(7)
  v_mfma_f32_16x16x32_bf16 v[24:27], a[96:99], v[64:67], v[24:27]
  v_mfma_f32_16x16x32_bf16 v[28:31], a[100:103], v[64:67], v[28:31]
  v_mfma_f32_16x16x32_bf16 v[32:35], a[104:107], v[64:67], v[32:35]
  v_mfma_f32_16x16x32_bf16 v[36:39], a[108:111], v[64:67], v[36:39]
  s_waitcnt vmcnt(6)
  v_mfma_f32_16x16x32_bf16 v[24:27], a[112:115], v[68:71], v[24:27]
  v_mfma_f32_16x16x32_bf16 v[28:31], a[116:119], v[68:71], v[28:31]
  v_mfma_f32_16x16x32_bf16 v[32:35], a[120:123], v[68:71], v[32:35]
  v_mfma_f32_16x16x32_bf16 v[36:39], a[124:127], v[68:71], v[36:39]
  s_waitcnt vmcnt(5)
  v_mfma_f32_16x16x32_bf16 v[24:27], a[128:131], v[72:75], v[24:27]
  v_mfma_f32_16x16x32_bf16 v[28:31], a[132:135], v[72:75], v[28:31]
  v_mfma_f32_16x16x32_bf16 v[32:35], a[136:139], v[72:75], v[32:35]
  v_mfma_f32_16x16x32_bf16 v[36:39], a[140:143], v[72:75], v[36:39]
  s_waitcnt vmcnt(4)
  v_mfma_f32_16x16x32_bf16 v[24:27], a[144:147], v[76:79], v[24:27]
  v_mfma_f32_16x16x32_bf16 v[28:31], a[148:151], v[76:79], v[28:31]
  v_mfma_f32_16x16x32_bf16 v[32:35], a[152:155], v[76:79], v[32:35]
  v_mfma_f32_16x16x32_bf16 v[36:39], a[156:159], v[76:79], v[36:39]
  s_waitcnt vmcnt(3)
  v_mfma_f32_16x16x32_bf16 v[24:27], a[160:163], v[80:83], v[24:27]
  v_mfma_f32_16x16x32_bf16 v[28:31], a[164:167], v[80:83], v[28:31]
  v_mfma_f32_16x16x32_bf16 v[32:35], a[168:171], v[80:83], v[32:35]
  v_mfma_f32_16x16x32_bf16 v[36:39], a[172:175], v[80:83], v[36:39]
  s_waitcnt vmcnt(2)
  v_mfma_f32_16x16x32_bf16 v[24:27], a[176:179], v[84:87], v[24:27]
  v_mfma_f32_16x16x32_bf16 v[28:31], a[180:183], v[84:87], v[28:31]
  v_mfma_f32_16x16x32_bf16 v[32:35], a[184:187], v[84:87], v[32:35]
  v_mfma_f32_16x16x32_bf16 v[36:39], a[188:191], v[84:87], v[36:39]
  s_waitcnt vmcnt(1)
  v_mfma_f32_16x16x32_bf16 v[24:27], a[192:195], v[88:91], v[24:27]
  v_mfma_f32_16x16x32_bf16 v[28:31], a[196:199], v[88:91], v[28:31]
  v_mfma_f32_16x16x32_bf16 v[32:35], a[200:203], v[88:91], v[32:35]
  v_mfma_f32_16x16x32_bf16 v[36:39], a[204:207], v[88:91], v[36:39]
  s_waitcnt vmcnt(0)
  v_mfma_f32_16x16x32_bf16 v[24:27], a[208:211], v[92:95], v[24:27]
  v_mfma_f32_16x16x32_bf16 v[28:31], a[212:215], v[92:95], v[28:31]
  v_mfma_f32_16x16x32_bf16 v[32:35], a[216:219], v[92:95], v[32:35]
  v_mfma_f32_16x16x32_bf16 v[36:39], a[220:223], v[92:95], v[36:39]
  v_lshlrev_b32 v88, 16, v216
  v_and_b32 v89, s92, v216
  v_lshlrev_b32 v90, 16, v217
  v_and_b32 v91, s92, v217
  v_lshlrev_b32 v92, 16, v218
  v_and_b32 v93, s92, v218
  v_lshlrev_b32 v94, 16, v219
  v_and_b32 v95, s92, v219
  v_lshlrev_b32 v96, 16, v220
  v_and_b32 v97, s92, v220
  v_lshlrev_b32 v98, 16, v221
  v_and_b32 v99, s92, v221
  v_lshlrev_b32 v100, 16, v222
  v_and_b32 v101, s92, v222
  v_lshlrev_b32 v102, 16, v223
  v_and_b32 v103, s92, v223
  v_lshlrev_b32 v104, 16, v208
  v_and_b32 v105, s92, v208
  v_lshlrev_b32 v106, 16, v209
  v_and_b32 v107, s92, v209
  v_lshlrev_b32 v108, 16, v210
  v_and_b32 v109, s92, v210
  v_lshlrev_b32 v110, 16, v211
  v_and_b32 v111, s92, v211
  v_lshlrev_b32 v112, 16, v212
  v_and_b32 v113, s92, v212
  v_lshlrev_b32 v114, 16, v213
  v_and_b32 v115, s92, v213
  v_lshlrev_b32 v116, 16, v214
  v_and_b32 v117, s92, v214
  v_lshlrev_b32 v118, 16, v215
  v_and_b32 v119, s92, v215
  s_waitcnt lgkmcnt(0)
  s_barrier
  ds_read_b128 v[40:43], v4 offset:0
  ds_read_b128 v[44:47], v4 offset:1024
  ds_read_b128 v[48:51], v4 offset:2048
  ds_read_b128 v[52:55], v4 offset:3072
  ds_read_b128 v[56:59], v4 offset:4096
  ds_read_b128 v[60:63], v4 offset:5120
  ds_read_b128 v[64:67], v4 offset:6144
  ds_read_b128 v[68:71], v4 offset:7168
  ds_read_b128 v[72:75], v4 offset:8192
  ds_read_b128 v[76:79], v4 offset:9216
  ds_read_b128 v[80:83], v4 offset:10240
  ds_read_b128 v[84:87], v4 offset:11264
  v_pk_add_f32 v[24:25], v[24:25], v[88:89]
  v_pk_add_f32 v[26:27], v[26:27], v[90:91]
  v_pk_add_f32 v[28:29], v[28:29], v[92:93]
  v_pk_add_f32 v[30:31], v[30:31], v[94:95]
  v_pk_add_f32 v[32:33], v[32:33], v[96:97]
  v_pk_add_f32 v[34:35], v[34:35], v[98:99]
  v_pk_add_f32 v[36:37], v[36:37], v[100:101]
  v_pk_add_f32 v[38:39], v[38:39], v[102:103]
  s_waitcnt lgkmcnt(8)
  v_pk_add_f32 v[24:25], v[24:25], v[40:41]
  v_pk_add_f32 v[26:27], v[26:27], v[42:43]
  v_pk_add_f32 v[28:29], v[28:29], v[44:45]
  v_pk_add_f32 v[30:31], v[30:31], v[46:47]
  v_pk_add_f32 v[32:33], v[32:33], v[48:49]
  v_pk_add_f32 v[34:35], v[34:35], v[50:51]
  v_pk_add_f32 v[36:37], v[36:37], v[52:53]
  v_pk_add_f32 v[38:39], v[38:39], v[54:55]
  s_waitcnt lgkmcnt(4)
  v_pk_add_f32 v[24:25], v[24:25], v[56:57]
  v_pk_add_f32 v[26:27], v[26:27], v[58:59]
  v_pk_add_f32 v[28:29], v[28:29], v[60:61]
  v_pk_add_f32 v[30:31], v[30:31], v[62:63]
  v_pk_add_f32 v[32:33], v[32:33], v[64:65]
  v_pk_add_f32 v[34:35], v[34:35], v[66:67]
  v_pk_add_f32 v[36:37], v[36:37], v[68:69]
  v_pk_add_f32 v[38:39], v[38:39], v[70:71]
  s_waitcnt lgkmcnt(0)
  v_pk_add_f32 v[24:25], v[24:25], v[72:73]
  v_pk_add_f32 v[26:27], v[26:27], v[74:75]
  v_pk_add_f32 v[28:29], v[28:29], v[76:77]
  v_pk_add_f32 v[30:31], v[30:31], v[78:79]
  v_pk_add_f32 v[32:33], v[32:33], v[80:81]
  v_pk_add_f32 v[34:35], v[34:35], v[82:83]
  v_pk_add_f32 v[36:37], v[36:37], v[84:85]
  v_pk_add_f32 v[38:39], v[38:39], v[86:87]
  v_cvt_pk_bf16_f32 v40, v24, v25
  v_cvt_pk_bf16_f32 v41, v26, v27
  v_cvt_pk_bf16_f32 v42, v28, v29
  v_cvt_pk_bf16_f32 v43, v30, v31
  v_cvt_pk_bf16_f32 v44, v32, v33
  v_cvt_pk_bf16_f32 v45, v34, v35
  v_cvt_pk_bf16_f32 v46, v36, v37
  v_cvt_pk_bf16_f32 v47, v38, v39
  v_lshlrev_b32 v24, 16, v40
  v_and_b32 v25, s92, v40
  v_lshlrev_b32 v26, 16, v41
  v_and_b32 v27, s92, v41
  v_lshlrev_b32 v28, 16, v42
  v_and_b32 v29, s92, v42
  v_lshlrev_b32 v30, 16, v43
  v_and_b32 v31, s92, v43
  v_lshlrev_b32 v32, 16, v44
  v_and_b32 v33, s92, v44
  v_lshlrev_b32 v34, 16, v45
  v_and_b32 v35, s92, v45
  v_lshlrev_b32 v36, 16, v46
  v_and_b32 v37, s92, v46
  v_lshlrev_b32 v38, 16, v47
  v_and_b32 v39, s92, v47
  v_pk_add_f32 v[24:25], v[24:25], v[104:105]
  v_pk_add_f32 v[26:27], v[26:27], v[106:107]
  v_pk_add_f32 v[28:29], v[28:29], v[108:109]
  v_pk_add_f32 v[30:31], v[30:31], v[110:111]
  v_pk_add_f32 v[32:33], v[32:33], v[112:113]
  v_pk_add_f32 v[34:35], v[34:35], v[114:115]
  v_pk_add_f32 v[36:37], v[36:37], v[116:117]
  v_pk_add_f32 v[38:39], v[38:39], v[118:119]
  v_cvt_pk_bf16_f32 v40, v24, v25
  v_cvt_pk_bf16_f32 v41, v26, v27
  v_cvt_pk_bf16_f32 v42, v28, v29
  v_cvt_pk_bf16_f32 v43, v30, v31
  v_cvt_pk_bf16_f32 v44, v32, v33
  v_cvt_pk_bf16_f32 v45, v34, v35
  v_cvt_pk_bf16_f32 v46, v36, v37
  v_cvt_pk_bf16_f32 v47, v38, v39
  v_permlane16_swap_b32 v40, v42
  v_permlane16_swap_b32 v41, v43
  v_permlane16_swap_b32 v44, v46
  v_permlane16_swap_b32 v45, v47
  v_and_b32 v4, 15, v1
  v_lshlrev_b32 v4, 10, v4
  v_bfe_u32 v5, v1, 4, 1
  v_lshl_add_u32 v4, v5, 5, v4
  v_lshrrev_b32 v5, 5, v1
  v_lshl_add_u32 v4, v5, 4, v4
  s_lshl_b32 s59, s4, 18
  s_lshl_b32 s60, s95, 16
  s_add_u32 s59, s59, s60
  s_lshl_b32 s60, s6, 14
  s_add_u32 s59, s59, s60
  s_lshl_b32 s60, s96, 7
  s_add_u32 s59, s59, s60
  buffer_store_dwordx4 v[40:43], v4, s[36:39], s59 offen offset:0
  buffer_store_dwordx4 v[44:47], v4, s[36:39], s59 offen offset:64
L_end:
L_exit:
  s_endpgm
L_codeend:
.section .rodata,"a"
.p2align 6
.amdhsa_kernel interleave_layers__ssm_conv_h3__mixer_channel_mlp__prompt_kernel
  .amdhsa_next_free_vgpr 512
  .amdhsa_next_free_sgpr 102
  .amdhsa_accum_offset 256
  .amdhsa_group_segment_fixed_size 0
  .amdhsa_kernarg_size 112
  .amdhsa_user_sgpr_count 2
  .amdhsa_user_sgpr_kernarg_segment_ptr 1
  .amdhsa_system_sgpr_workgroup_id_x 1
.end_amdhsa_kernel
```
